```python
import torch

def _softmax(x, axis=-1):
    return torch.softmax(x, dim=axis)

def _gelu(x):
    return torch.nn.functional.gelu(x, approximate='tanh')

def _silu(x):
    return torch.nn.functional.silu(x)

def _sigmoid(x):
    return torch.sigmoid(x)

def _layernorm(x, axis=-1, eps=1e-05):
    m = x.mean(dim=axis, keepdim=True)
    v = x.var(dim=axis, keepdim=True, unbiased=False)
    return (x - m) / torch.sqrt(v + eps)

def _scatter_add(tgt, idx, src, axis=0):
    return tgt.clone().index_add_(axis, idx, src)

def _segment_sum(src, seg, n):
    out = torch.zeros((n,) + src.shape[1:], dtype=src.dtype)
    return out.index_add_(0, seg, src)

def _pad(x, pw):
    flat = tuple((v for pair in reversed(pw) for v in pair))
    return torch.nn.functional.pad(x, flat)
kernel_name = 'adaLN_cond__compressed_kv_cla__glu_gated_geglu__decode'

def setup_inputs():

    _w = lambda a: (lambda t: t.to(torch.bfloat16) if t.is_floating_point() else t)(torch.as_tensor(a))

    def _A_setup():
        B, H, Sq, Sk, D, M = (2, 32, 1, 8192, 128, 512)
        Dc = 4 * D
        return {'x': _w((lambda *s: torch.randn(*s, dtype=torch.bfloat16) * 0.05)(B, Sq, M)), 'c_kv': _w((lambda *s: torch.randn(*s, dtype=torch.bfloat16) * 3.2)(B, Sk, Dc)), 'w_q': _w((lambda *s: torch.randn(*s, dtype=torch.bfloat16) * 0.8)(M, H, D) * M ** (-0.5)), 'w_uk': _w((lambda *s: torch.randn(*s, dtype=torch.bfloat16) * 0.8)(Dc, H, D) * Dc ** (-0.5)), 'w_uv': _w((lambda *s: torch.randn(*s, dtype=torch.bfloat16) * 3.2)(Dc, H, D) * Dc ** (-0.5)), 'w_o': _w((lambda *s: torch.randn(*s, dtype=torch.bfloat16) * 3.2)(H, D, M) * (H * D) ** (-0.5))}
    _A_in = _A_setup()

    def _B_setup():
        B, S, Dm, Df = (2, 1, 512, 1792)
        return {'x': _w((lambda *s: torch.randn(*s, dtype=torch.bfloat16) * 0.05)(B, S, Dm)), 'w_gate': _w((lambda *s: torch.randn(*s, dtype=torch.bfloat16) * 3.2)(Dm, Df) * Dm ** (-0.5)), 'w_up': _w((lambda *s: torch.randn(*s, dtype=torch.bfloat16) * 3.2)(Dm, Df) * Dm ** (-0.5)), 'w_down': _w((lambda *s: torch.randn(*s, dtype=torch.bfloat16) * 3.2)(Df, Dm) * Df ** (-0.5))}
    _B_in = _B_setup()
    return {'A_x': _A_in['x'], 'A_c_kv': _A_in['c_kv'], 'A_w_q': _A_in['w_q'], 'A_w_uk': _A_in['w_uk'], 'A_w_uv': _A_in['w_uv'], 'A_w_o': _A_in['w_o'], 'B_x': _B_in['x'], 'B_w_gate': _B_in['w_gate'], 'B_w_up': _B_in['w_up'], 'B_w_down': _B_in['w_down'], 'c': _w((lambda *s: torch.randn(*s, dtype=torch.bfloat16) * 0.1)(2, 512) * 8.0), 'w_mod': _w((lambda *s: torch.randn(*s, dtype=torch.bfloat16) * 0.1)(512, 6 * 512) * 512 ** (-0.5) * 8.0)}

def reference(A_x, A_c_kv, A_w_q, A_w_uk, A_w_uv, A_w_o, B_x, B_w_gate, B_w_up, B_w_down, c, w_mod):

    def _A_ref(x, c_kv, w_q, w_uk, w_uv, w_o):
        B, Sq, M = (x.shape[0], x.shape[1], x.shape[2])
        Sk = c_kv.shape[1]
        H, D = (w_q.shape[1], w_q.shape[2])
        q = torch.einsum('bqm,mhd->bhqd', x, w_q)
        k = torch.einsum('bkc,chd->bhkd', c_kv, w_uk)
        v = torch.einsum('bkc,chd->bhkd', c_kv, w_uv)
        scores = torch.einsum('bhqd,bhkd->bhqk', q, k) * D ** (-0.5)
        off = Sk - Sq
        qi = torch.arange(Sq)[:, None]
        kj = torch.arange(Sk)[None, :]
        cmask = kj <= qi + off
        scores = torch.where(cmask[None, None], scores, -1000000000.0)
        p = _softmax(scores, axis=-1)
        ctx = torch.einsum('bhqk,bhkd->bhqd', p, v)
        return torch.einsum('bhqd,hdm->bqm', ctx, w_o)

    def _B_ref(x, w_gate, w_up, w_down):
        g = torch.einsum('bsd,df->bsf', x, w_gate)
        u = torch.einsum('bsd,df->bsf', x, w_up)
        h = _gelu(g) * u
        return torch.einsum('bsf,fd->bsd', h, w_down)
    x = A_x
    mod = (_silu(c) @ w_mod).reshape(c.shape[0], 6, 1, -1)
    sa, ca, ga, sb, cb, gb = (mod[:, 0].clone(), mod[:, 1].clone(), mod[:, 2].clone(), mod[:, 3].clone(), mod[:, 4].clone(), mod[:, 5].clone())
    h = _layernorm(x, axis=-1) * (1 + ca) + sa
    x = x + ga * _A_ref(h, A_c_kv, A_w_q, A_w_uk, A_w_uv, A_w_o)
    h = _layernorm(x, axis=-1) * (1 + cb) + sb
    x = x + gb * _B_ref(h, B_w_gate, B_w_up, B_w_down)
    return x
```

```asm
; @launch grid=(256,1,1) block=(512,1,1) lds=161536
.amdgcn_target "amdgcn-amd-amdhsa--gfx950"
.text
.globl adaLN_cond__compressed_kv_cla__glu_gated_geglu__decode_kernel
.p2align 12
.p2align 8
.type adaLN_cond__compressed_kv_cla__glu_gated_geglu__decode_kernel,@function
adaLN_cond__compressed_kv_cla__glu_gated_geglu__decode_kernel:
  s_cmp_ge_u32 s2, 256
  s_cbranch_scc1 L_exit
  s_load_dwordx16 s[16:31], s[0:1], 0
  s_load_dwordx8 s[32:39], s[0:1], 64
  s_load_dwordx4 s[40:43], s[0:1], 96
  s_load_dwordx2 s[44:45], s[0:1], 112
  s_and_b32 s64, s2, 224
  s_cmp_lg_u32 s64, 64
  s_cbranch_scc1 L_nocpf
  s_getpc_b64 s[64:65]
L_pcref:
  v_lshlrev_b32 v9, 7, v0
  v_min_u32 v9, L_exit-L_pcref, v9
  global_load_dword v64, v9, s[64:65]
  s_nop 0
L_nocpf:
  s_memrealtime s[94:95]
  v_and_b32 v1, 63, v0
  v_lshrrev_b32 v4, 6, v0
  v_mov_b32 v2, 0
  v_mov_b32 v3, 1
  v_mov_b32 v15, 0x7ff00000
  v_writelane_b32 v15, 0, 0
  v_readfirstlane_b32 s3, v4
  s_and_b32 s4, s2, 7
  s_lshr_b32 s5, s2, 3
  s_and_b32 s6, s3, 3
  s_mov_b32 s7, 3000000
  s_mov_b32 s86, 0x05040100
  s_mov_b32 s87, 0x07060302
  v_lshlrev_b32 v4, 2, v1
  ds_write_b32 v4, v2 offset:26112
  v_and_b32 v6, 15, v1
  v_lshrrev_b32 v7, 4, v1
  v_lshlrev_b32 v8, 4, v1
  v_and_b32 v10, 255, v0
  s_bfe_u32 s92, s5, 65539
  s_lshr_b32 s91, s5, 4
  s_lshl_b32 s91, s91, 3
  s_and_b32 s64, s5, 7
  s_or_b32 s91, s91, s64
  s_lshl_b32 s47, s91, 3
  s_add_u32 s47, s47, s4
  s_lshr_b32 s90, s91, 2
  s_and_b32 s46, s91, 3
  s_lshl_b32 s46, s46, 3
  s_add_u32 s46, s46, s4
  s_lshl_b32 s64, s91, 3
  s_and_b32 s64, s64, 63
  s_lshl_b64 s[96:97], -1, s64
  s_lshr_b32 s93, s3, 2
  s_xor_b32 s93, s93, 1
  s_cmp_eq_u32 s92, 1
  s_cbranch_scc1 L_N
  s_setprio 2
  s_and_b32 s101, s91, 7
  s_lshr_b32 s100, s91, 3
  s_lshl_b32 s64, s4, 1
  s_add_u32 s100, s100, s64
  v_bfe_u32 v14, v1, 2, 3
  v_add_u32 v11, s101, v14
  v_and_b32 v11, 7, v11
  v_lshlrev_b32 v11, 7, v11
  v_and_b32 v12, 3, v1
  v_lshl_add_u32 v11, v12, 2, v11
  v_lshrrev_b32 v13, 5, v1
  v_lshl_add_u32 v11, v13, 10, v11
  s_lshr_b32 s92, s91, 1
  s_and_b32 s92, s92, 4
  s_add_u32 s92, s92, s101
  s_add_u32 s77, s3, s92
  s_and_b32 s77, s77, 7
  s_lshl_b32 s67, s77, 4
  v_lshrrev_b32 v5, 3, v6
  v_lshl_add_u32 v5, v5, 2, v7
  v_mul_u32_u24 v63, 6144, v5
  v_lshl_add_u32 v9, v12, 4, v63
  v_and_b32 v5, 4, v1
  v_lshl_add_u32 v9, v5, 8, v9
  s_mul_i32 s64, s77, 49152
  s_lshl_b32 s65, s100, 6
  s_add_u32 s64, s64, s65
  s_mul_i32 s66, s101, 393216
  s_mov_b32 s50, 3145728
  s_mov_b32 s51, 0x00020000
  s_mov_b32 s54, 2048
  s_mov_b32 s55, 0x00020000
  s_waitcnt lgkmcnt(0)
  s_mov_b32 s52, s36
  s_mov_b32 s53, s37
  s_mov_b32 s48, s38
  s_mov_b32 s49, s39
  buffer_load_dword v16, v11, s[52:55], s67 offen
  s_mov_b32 s28, s100
  s_mov_b32 s29, s101
  s_cmp_lg_u32 s3, 4
  s_cbranch_scc1 L_F_nox
  s_mov_b32 s60, s16
  s_mov_b32 s61, s17
  s_mov_b32 s62, 2048
  s_mov_b32 s63, 0x00020000
  v_and_b32 v17, 31, v1
  v_lshlrev_b32 v18, 10, v13
  v_lshl_add_u32 v19, v17, 5, v18
  v_lshl_add_u32 v17, v17, 1, v18
  buffer_load_dwordx4 v[20:23], v19, s[60:63], 0 offen
  buffer_load_dwordx4 v[24:27], v19, s[60:63], 0 offen offset:16
  buffer_load_ushort v28, v17, s[60:63], s65 offen
L_F_nox:
  s_add_u32 s67, s64, s66
  buffer_load_dwordx4 v[64:67], v9, s[48:51], s67 offen
  s_add_u32 s66, s66, 393216
  s_cmp_eq_u32 s66, 3145728
  s_cselect_b32 s66, 0, s66
  s_add_u32 s67, s64, s66
  buffer_load_dwordx4 v[68:71], v9, s[48:51], s67 offen
  s_add_u32 s66, s66, 393216
  s_cmp_eq_u32 s66, 3145728
  s_cselect_b32 s66, 0, s66
  s_add_u32 s67, s64, s66
  buffer_load_dwordx4 v[72:75], v9, s[48:51], s67 offen
  s_add_u32 s66, s66, 393216
  s_cmp_eq_u32 s66, 3145728
  s_cselect_b32 s66, 0, s66
  s_add_u32 s67, s64, s66
  buffer_load_dwordx4 v[76:79], v9, s[48:51], s67 offen
  s_add_u32 s66, s66, 393216
  s_cmp_eq_u32 s66, 3145728
  s_cselect_b32 s66, 0, s66
  s_add_u32 s67, s64, s66
  buffer_load_dwordx4 v[80:83], v9, s[48:51], s67 offen
  s_add_u32 s66, s66, 393216
  s_cmp_eq_u32 s66, 3145728
  s_cselect_b32 s66, 0, s66
  s_add_u32 s67, s64, s66
  buffer_load_dwordx4 v[84:87], v9, s[48:51], s67 offen
  s_add_u32 s66, s66, 393216
  s_cmp_eq_u32 s66, 3145728
  s_cselect_b32 s66, 0, s66
  s_add_u32 s67, s64, s66
  buffer_load_dwordx4 v[88:91], v9, s[48:51], s67 offen
  s_add_u32 s66, s66, 393216
  s_cmp_eq_u32 s66, 3145728
  s_cselect_b32 s66, 0, s66
  s_add_u32 s67, s64, s66
  buffer_load_dwordx4 v[92:95], v9, s[48:51], s67 offen
  s_mov_b32 s8, s44
  s_mov_b32 s9, s45
  s_mov_b32 s10, 16777216
  s_mov_b32 s11, 0x00020000
  s_mov_b32 s56, s42
  s_mov_b32 s57, s43
  s_mov_b32 s58, 256
  s_mov_b32 s59, 0x00020000
  s_cmp_ge_u32 s3, 4
  s_cbranch_scc1 L_FB
  s_mov_b32 s12, s20
  s_mov_b32 s13, s21
  s_mov_b32 s14, 4194304
  s_mov_b32 s15, 0x00020000
  v_lshlrev_b32 v9, 16, v7
  v_lshl_add_u32 v9, v6, 4, v9
  s_lshl_b32 s62, s29, 2
  s_add_u32 s62, s62, s6
  s_lshl_b32 s66, s62, 8
  s_lshl_b32 s65, s28, 18
  s_add_u32 s66, s66, s65
  s_barrier
  buffer_load_dwordx4 v[128:131], v9, s[12:15], s66 offen
  s_add_u32 s66, s66, 8192
  buffer_load_dwordx4 v[132:135], v9, s[12:15], s66 offen
  s_add_u32 s66, s66, 8192
  buffer_load_dwordx4 v[136:139], v9, s[12:15], s66 offen
  s_add_u32 s66, s66, 8192
  buffer_load_dwordx4 v[140:143], v9, s[12:15], s66 offen
  s_add_u32 s66, s66, 8192
  buffer_load_dwordx4 v[144:147], v9, s[12:15], s66 offen
  s_add_u32 s66, s66, 8192
  buffer_load_dwordx4 v[148:151], v9, s[12:15], s66 offen
  s_add_u32 s66, s66, 8192
  buffer_load_dwordx4 v[152:155], v9, s[12:15], s66 offen
  s_add_u32 s66, s66, 8192
  buffer_load_dwordx4 v[156:159], v9, s[12:15], s66 offen
  s_lshl_b32 s64, s3, 8
  v_lshrrev_b32 v5, 1, v12
  v_lshlrev_b32 v5, 7, v5
  v_lshl_add_u32 v5, v13, 6, v5
  v_and_b32 v12, 1, v1
  v_lshl_add_u32 v5, v12, 5, v5
  v_lshl_add_u32 v5, v14, 1, v5
  v_add_u32 v5, s64, v5
  v_bfe_u32 v11, v6, 2, 1
  v_lshlrev_b32 v11, 7, v11
  v_lshl_add_u32 v11, v12, 6, v11
  v_lshl_add_u32 v11, v7, 4, v11
  v_add_u32 v12, s64, v11
  s_lshl_b32 s64, s3, 10
  s_add_u32 s64, s64, 4352
  v_lshl_add_u32 v14, v6, 6, s64
  s_mov_b32 s65, 3216550459
  s_waitcnt vmcnt(16)
  v_and_b32 v17, 0xffff0000, v16
  v_lshlrev_b32 v16, 16, v16
  v_mul_f32 v18, s65, v16
  v_mul_f32 v19, s65, v17
  v_exp_f32 v18, v18
  v_exp_f32 v19, v19
  v_add_f32 v18, 1.0, v18
  v_add_f32 v19, 1.0, v19
  v_rcp_f32 v18, v18
  v_rcp_f32 v19, v19
  v_mul_f32 v16, v16, v18
  v_mul_f32 v17, v17, v19
  v_cvt_pk_bf16_f32 v16, v16, v17
  ds_write_b16 v5, v16 offset:2304
  ds_write_b16_d16_hi v5, v16 offset:2320
  ds_read_b128 v[48:51], v12 offset:2304
  s_lshl_b32 s60, s62, 14
  s_lshl_b32 s65, s28, 10
  s_add_u32 s60, s60, s65
  s_add_u32 s60, s60, 1277952
  v_lshlrev_b32 v13, 4, v13
  v_lshl_add_u32 v13, v6, 5, v13
  v_and_b32 v60, 1, v7
  v_lshl_add_u32 v13, v60, 9, v13
  v_lshlrev_b32 v62, 3, v1
  v_add_u32 v62, 4352, v62
  v_lshlrev_b32 v61, 2, v1
  s_lshl_b32 s64, s6, 7
  v_lshl_add_u32 v60, v1, 1, s64
  v_bfe_u32 v55, v6, 2, 1
  v_lshlrev_b32 v55, 6, v55
  v_lshl_add_u32 v55, v7, 4, v55
  v_add_u32 v55, s64, v55
  s_waitcnt vmcnt(12)
  v_perm_b32 v96, v68, v64, s86
  v_perm_b32 v100, v68, v64, s87
  v_perm_b32 v97, v76, v72, s86
  v_perm_b32 v101, v76, v72, s87
  v_perm_b32 v104, v69, v65, s86
  v_perm_b32 v108, v69, v65, s87
  v_perm_b32 v105, v77, v73, s86
  v_perm_b32 v109, v77, v73, s87
  v_perm_b32 v112, v70, v66, s86
  v_perm_b32 v116, v70, v66, s87
  v_perm_b32 v113, v78, v74, s86
  v_perm_b32 v117, v78, v74, s87
  v_perm_b32 v120, v71, v67, s86
  v_perm_b32 v124, v71, v67, s87
  v_perm_b32 v121, v79, v75, s86
  v_perm_b32 v125, v79, v75, s87
  s_waitcnt vmcnt(8)
  v_perm_b32 v98, v84, v80, s86
  v_perm_b32 v102, v84, v80, s87
  v_perm_b32 v99, v92, v88, s86
  v_perm_b32 v103, v92, v88, s87
  v_perm_b32 v106, v85, v81, s86
  v_perm_b32 v110, v85, v81, s87
  v_perm_b32 v107, v93, v89, s86
  v_perm_b32 v111, v93, v89, s87
  v_perm_b32 v114, v86, v82, s86
  v_perm_b32 v118, v86, v82, s87
  v_perm_b32 v115, v94, v90, s86
  v_perm_b32 v119, v94, v90, s87
  v_perm_b32 v122, v87, v83, s86
  v_perm_b32 v126, v87, v83, s87
  v_perm_b32 v123, v95, v91, s86
  v_perm_b32 v127, v95, v91, s87
  s_waitcnt lgkmcnt(0)
  v_mfma_f32_16x16x32_bf16 v[16:19], v[48:51], v[96:99], 0
  v_mfma_f32_16x16x32_bf16 v[20:23], v[48:51], v[100:103], 0
  v_mfma_f32_16x16x32_bf16 v[24:27], v[48:51], v[104:107], 0
  v_mfma_f32_16x16x32_bf16 v[28:31], v[48:51], v[108:111], 0
  v_mfma_f32_16x16x32_bf16 v[32:35], v[48:51], v[112:115], 0
  v_mfma_f32_16x16x32_bf16 v[36:39], v[48:51], v[116:119], 0
  v_mfma_f32_16x16x32_bf16 v[40:43], v[48:51], v[120:123], 0
  v_mfma_f32_16x16x32_bf16 v[44:47], v[48:51], v[124:127], 0
  s_mov_b32 exec_lo, 0xff0000ff
  s_mov_b32 exec_hi, 0
  ds_write2_b64 v14, v[16:17], v[20:21] offset0:0 offset1:1
  s_nop 0
  ds_write2_b64 v14, v[24:25], v[28:29] offset0:2 offset1:3
  s_nop 0
  ds_write2_b64 v14, v[32:33], v[36:37] offset0:4 offset1:5
  s_nop 0
  ds_write2_b64 v14, v[40:41], v[44:45] offset0:6 offset1:7
  s_mov_b64 exec, -1
  ds_add_u32 v15, v3 offset:26112
  s_waitcnt vmcnt(4)
  v_perm_b32 v160, v132, v128, s86
  v_perm_b32 v164, v132, v128, s87
  v_perm_b32 v161, v140, v136, s86
  v_perm_b32 v165, v140, v136, s87
  v_perm_b32 v168, v133, v129, s86
  v_perm_b32 v172, v133, v129, s87
  v_perm_b32 v169, v141, v137, s86
  v_perm_b32 v173, v141, v137, s87
  v_perm_b32 v176, v134, v130, s86
  v_perm_b32 v180, v134, v130, s87
  v_perm_b32 v177, v142, v138, s86
  v_perm_b32 v181, v142, v138, s87
  v_perm_b32 v184, v135, v131, s86
  v_perm_b32 v188, v135, v131, s87
  v_perm_b32 v185, v143, v139, s86
  v_perm_b32 v189, v143, v139, s87
  s_waitcnt vmcnt(0)
  v_perm_b32 v162, v148, v144, s86
  v_perm_b32 v166, v148, v144, s87
  v_perm_b32 v163, v156, v152, s86
  v_perm_b32 v167, v156, v152, s87
  v_perm_b32 v170, v149, v145, s86
  v_perm_b32 v174, v149, v145, s87
  v_perm_b32 v171, v157, v153, s86
  v_perm_b32 v175, v157, v153, s87
  v_perm_b32 v178, v150, v146, s86
  v_perm_b32 v182, v150, v146, s87
  v_perm_b32 v179, v158, v154, s86
  v_perm_b32 v183, v158, v154, s87
  v_perm_b32 v186, v151, v147, s86
  v_perm_b32 v190, v151, v147, s87
  v_perm_b32 v187, v159, v155, s86
  v_perm_b32 v191, v159, v155, s87
  s_nop 1
L_wc_1:
  ds_read_b32 v4, v2 offset:26112
  s_waitcnt lgkmcnt(0)
  v_readfirstlane_b32 s68, v4
  s_cmp_ge_u32 s68, 8
  s_nop 2
  s_cbranch_scc1 L_wcd_2
  s_sub_u32 s7, s7, 1
  s_cbranch_scc0 L_wc_1
  s_branch L_exit
L_wcd_2:
  ds_read2st64_b64 v[16:19], v62 offset0:0 offset1:1
  ds_read2st64_b64 v[20:23], v62 offset0:2 offset1:3
  ds_read2st64_b64 v[24:27], v62 offset0:4 offset1:5
  ds_read2st64_b64 v[28:31], v62 offset0:6 offset1:7
  ds_read2st64_b64 v[32:35], v62 offset0:8 offset1:9
  ds_read2st64_b64 v[36:39], v62 offset0:10 offset1:11
  ds_read2st64_b64 v[40:43], v62 offset0:12 offset1:13
  ds_read2st64_b64 v[44:47], v62 offset0:14 offset1:15
  ds_read_b32 v54, v61 offset:13056
  s_waitcnt lgkmcnt(0)
  v_pk_add_f32 v[16:17], v[16:17], v[18:19]
  v_pk_add_f32 v[20:21], v[20:21], v[22:23]
  v_pk_add_f32 v[24:25], v[24:25], v[26:27]
  v_pk_add_f32 v[28:29], v[28:29], v[30:31]
  v_pk_add_f32 v[32:33], v[32:33], v[34:35]
  v_pk_add_f32 v[36:37], v[36:37], v[38:39]
  v_pk_add_f32 v[40:41], v[40:41], v[42:43]
  v_pk_add_f32 v[44:45], v[44:45], v[46:47]
  v_pk_add_f32 v[16:17], v[16:17], v[20:21]
  v_pk_add_f32 v[24:25], v[24:25], v[28:29]
  v_pk_add_f32 v[32:33], v[32:33], v[36:37]
  v_pk_add_f32 v[40:41], v[40:41], v[44:45]
  v_pk_add_f32 v[16:17], v[16:17], v[24:25]
  v_pk_add_f32 v[32:33], v[32:33], v[40:41]
  v_pk_add_f32 v[16:17], v[16:17], v[32:33]
  s_nop 1
  v_permlane32_swap_b32 v16, v17
  v_add_f32 v17, 1.0, v17
  v_fmac_f32 v16, v54, v17
  v_cvt_pk_bf16_f32 v16, v16, v16
  ds_write_b16 v60, v16 offset:12544
  ds_read_b128 v[48:51], v55 offset:12544
  ds_read_b32 v4, v2 offset:26200
  ds_read_b32 v58, v2 offset:20096
  s_lshl_b32 s61, s46, 14
  s_lshl_b32 s64, s3, 11
  s_add_u32 s61, s61, s64
  s_add_u32 s61, s61, 1277952
  v_lshrrev_b32 v193, 5, v1
  s_lshl_b32 s64, s3, 1
  v_add_u32 v193, s64, v193
  v_mul_u32_u24 v193, 272, v193
  v_and_b32 v14, 31, v1
  v_lshl_add_u32 v193, v14, 3, v193
  s_movk_i32 s54, 0x3f80
  s_mov_b32 s55, 0x3f800000
  v_mov_b32 v16, 0
  v_mov_b32 v17, 0
  v_mov_b32 v18, 0
  v_mov_b32 v19, 0
  s_lshl_b32 s65, s46, 11
  s_lshl_b32 s64, s3, 8
  s_add_u32 s65, s65, s64
  s_add_u32 s65, s65, 1835008
  v_lshlrev_b32 v137, 7, v1
  s_mov_b64 s[70:71], 0
  s_mov_b64 s[72:73], 0
  s_mov_b64 s[74:75], 3
  s_mov_b32 s76, 0
  v_mov_b32 v130, 0
  v_mov_b32 v134, 0
  s_waitcnt lgkmcnt(2)
  v_mfma_f32_16x16x32_bf16 v[64:67], v[48:51], v[160:163], 0
  v_mfma_f32_16x16x32_bf16 v[68:71], v[48:51], v[164:167], 0
  s_waitcnt lgkmcnt(0)
  v_readfirstlane_b32 s68, v4
  v_mfma_f32_16x16x32_bf16 v[72:75], v[48:51], v[168:171], 0
  s_cmp_ge_u32 s68, 1
  s_cbranch_scc1 L_fre_ok
L_fre_w:
  ds_read_b32 v4, v2 offset:26200
  ds_read_b32 v58, v2 offset:20096
  s_waitcnt lgkmcnt(0)
  v_readfirstlane_b32 s68, v4
  s_cmp_ge_u32 s68, 1
  s_nop 2
  s_cbranch_scc1 L_fre_ok
  s_sub_u32 s7, s7, 1
  s_cbranch_scc0 L_fre_w
  s_branch L_exit
L_fre_ok:
  v_mfma_f32_16x16x32_bf16 v[76:79], v[48:51], v[172:175], 0
  v_not_b32 v59, v58
  v_readfirstlane_b32 s88, v58
  v_mfma_f32_16x16x32_bf16 v[80:83], v[48:51], v[176:179], 0
  s_not_b32 s89, s88
  v_mfma_f32_16x16x32_bf16 v[84:87], v[48:51], v[180:183], 0
  v_mfma_f32_16x16x32_bf16 v[88:91], v[48:51], v[184:187], 0
  v_mfma_f32_16x16x32_bf16 v[92:95], v[48:51], v[188:191], 0
  v_cvt_pk_bf16_f32 v56, v64, v68
  v_cvt_pk_bf16_f32 v57, v72, v76
  v_mov_b32 v183, v193
  s_mov_b32 exec_lo, 0
  s_nop 1
  v_cvt_pk_bf16_f32 v56, v80, v84
  s_nop 0
  v_cvt_pk_bf16_f32 v57, v88, v92
  s_mov_b32 exec_lo, -1
  buffer_store_dwordx4 v[56:59], v13, s[8:11], s60 offen sc1
  ds_add_u32 v15, v3 offset:26120
  s_nop 0
L_qq_5:
  s_mov_b64 exec, s[70:71]
  buffer_load_dwordx4 v[128:131], v8, s[8:11], s61 offen sc1
  s_mov_b64 exec, s[72:73]
  buffer_load_dwordx4 v[132:135], v8, s[8:11], s61 offen offset:1024 sc1
  s_mov_b64 exec, s[74:75]
  buffer_load_dword v136, v137, s[8:11], s65 offen sc1
  s_waitcnt vmcnt(0)
L_qq_5_c:
  v_cmp_ne_u32_e64 s[74:75], s88, v136
  s_mov_b64 exec, -1
  v_cmp_ne_u64_e64 s[70:71], s[88:89], v[130:131]
  v_cmp_ne_u64_e64 s[72:73], s[88:89], v[134:135]
  s_or_b64 s[68:69], s[70:71], s[72:73]
  s_nop 2
  s_cbranch_scc0 L_qqd_6
  s_bitcmp1_b32 s74, 0
  s_cselect_b64 s[70:71], 0, s[70:71]
  s_bitcmp1_b32 s74, 1
  s_cselect_b64 s[72:73], 0, s[72:73]
  s_sub_u32 s7, s7, 1
  s_cbranch_scc0 L_qq_5
  s_branch L_exit
L_qqd_6:
  v_dot2c_f32_bf16 v16, s54, v128
  v_dot2c_f32_bf16 v17, s55, v128
  v_dot2c_f32_bf16 v18, s54, v129
  v_dot2c_f32_bf16 v19, s55, v129
  v_dot2c_f32_bf16 v16, s54, v132
  v_dot2c_f32_bf16 v17, s55, v132
  v_dot2c_f32_bf16 v18, s54, v133
  v_dot2c_f32_bf16 v19, s55, v133
  s_nop 1
  v_cvt_pk_bf16_f32 v20, v16, v17
  s_nop 0
  v_cvt_pk_bf16_f32 v21, v18, v19
  ds_write_b64 v183, v[20:21] offset:13312
  ds_add_u32 v15, v3 offset:26204
  s_setprio 0
  v_and_b32 v9, 7, v1
  v_lshl_add_u32 v9, v9, 4, v63
  s_lshr_b32 s95, s28, 2
  s_lshl_b32 s64, s29, 2
  s_add_u32 s95, s95, s64
  s_bfe_u32 s65, s28, 0x10001
  s_lshl_b32 s65, s65, 2
  s_add_u32 s65, s65, s6
  s_add_u32 s64, s65, s92
  s_and_b32 s64, s64, 7
  s_mul_i32 s64, s64, 49152
  s_lshl_b32 s66, s95, 7
  s_add_u32 s64, s64, s66
  s_add_u32 s64, s64, 2048
  s_and_b32 s67, s28, 1
  s_lshl_b32 s66, s67, 2
  s_add_u32 s66, s66, s29
  s_and_b32 s66, s66, 7
  s_mul_i32 s66, s66, 393216
  s_lshl_b32 s65, s65, 8
  s_lshl_b32 s67, s67, 3
  s_add_u32 s65, s65, s67
  v_add_u32 v11, s65, v11
  ds_read_b64 v[240:241], v11 offset:2304
  s_nop 0
L_wc_7:
  ds_read_b32 v4, v2 offset:26172
  s_waitcnt lgkmcnt(0)
  v_readfirstlane_b32 s68, v4
  s_cmp_ge_u32 s68, 4
  s_nop 2
  s_cbranch_scc1 L_wcd_8
  s_sleep 2
  s_sub_u32 s7, s7, 1
  s_cbranch_scc0 L_wc_7
  s_branch L_exit
L_wcd_8:
  s_add_u32 s67, s64, s66
  buffer_load_dwordx4 v[208:211], v9, s[48:51], s67 offen
  s_add_u32 s66, s66, 393216
  s_cmp_eq_u32 s66, 3145728
  s_cselect_b32 s66, 0, s66
  s_add_u32 s67, s64, s66
  buffer_load_dwordx4 v[212:215], v9, s[48:51], s67 offen
  s_add_u32 s66, s66, 393216
  s_cmp_eq_u32 s66, 3145728
  s_cselect_b32 s66, 0, s66
  s_add_u32 s67, s64, s66
  buffer_load_dwordx4 v[216:219], v9, s[48:51], s67 offen
  s_add_u32 s66, s66, 393216
  s_cmp_eq_u32 s66, 3145728
  s_cselect_b32 s66, 0, s66
  s_add_u32 s67, s64, s66
  buffer_load_dwordx4 v[220:223], v9, s[48:51], s67 offen
  s_mov_b64 exec, -1
  s_branch L_V
L_FB:
  s_mov_b32 s12, s22
  s_mov_b32 s13, s23
  s_mov_b32 s14, 4194304
  s_mov_b32 s15, 0x00020000
  s_cmp_lg_u32 s6, 1
  s_cbranch_scc1 L_B_noepl
  s_mov_b64 exec, 1
  buffer_load_dword v61, v2, s[56:59], 0 offen offset:128 sc1
  s_mov_b64 exec, -1
L_B_noepl:
  v_lshrrev_b32 v182, 2, v6
  v_lshlrev_b32 v182, 2, v182
  v_add_u32 v182, v6, v182
  v_lshlrev_b32 v182, 13, v182
  v_lshl_add_u32 v182, v7, 4, v182
  s_lshl_b32 s66, s90, 7
  s_lshl_b32 s67, s6, 5
  s_add_u32 s66, s66, s67
  s_lshl_b32 s66, s66, 13
  s_lshl_b32 s67, s46, 8
  s_add_u32 s66, s66, s67
  s_barrier
  s_lshl_b32 s64, s3, 8
  v_lshrrev_b32 v5, 1, v12
  v_lshlrev_b32 v5, 7, v5
  v_lshl_add_u32 v5, v13, 6, v5
  v_and_b32 v12, 1, v1
  v_lshl_add_u32 v5, v12, 5, v5
  v_lshl_add_u32 v5, v14, 1, v5
  v_add_u32 v5, s64, v5
  v_bfe_u32 v11, v6, 2, 1
  v_lshlrev_b32 v11, 7, v11
  v_lshl_add_u32 v11, v12, 6, v11
  v_lshl_add_u32 v11, v7, 4, v11
  v_add_u32 v12, s64, v11
  s_lshl_b32 s64, s3, 10
  s_add_u32 s64, s64, 4352
  v_lshl_add_u32 v14, v6, 6, s64
  s_mov_b32 s65, 3216550459
  s_waitcnt vmcnt(8)
  v_and_b32 v17, 0xffff0000, v16
  v_lshlrev_b32 v16, 16, v16
  v_mul_f32 v18, s65, v16
  v_mul_f32 v19, s65, v17
  v_exp_f32 v18, v18
  v_exp_f32 v19, v19
  v_add_f32 v18, 1.0, v18
  v_add_f32 v19, 1.0, v19
  v_rcp_f32 v18, v18
  v_rcp_f32 v19, v19
  v_mul_f32 v16, v16, v18
  v_mul_f32 v17, v17, v19
  v_cvt_pk_bf16_f32 v16, v16, v17
  ds_write_b16 v5, v16 offset:2304
  ds_write_b16_d16_hi v5, v16 offset:2320
  ds_read_b128 v[48:51], v12 offset:2304
  s_cmp_lg_u32 s6, 0
  s_cbranch_scc1 L_B_noln
  v_mov_b32 v56, 0
  v_mov_b32 v57, 0
  v_mov_b32 v59, 0x3f803f80
  v_dot2c_f32_bf16 v56, v20, v59
  v_dot2c_f32_bf16 v57, v20, v20
  v_dot2c_f32_bf16 v56, v21, v59
  v_dot2c_f32_bf16 v57, v21, v21
  v_dot2c_f32_bf16 v56, v22, v59
  v_dot2c_f32_bf16 v57, v22, v22
  v_dot2c_f32_bf16 v56, v23, v59
  v_dot2c_f32_bf16 v57, v23, v23
  v_dot2c_f32_bf16 v56, v24, v59
  v_dot2c_f32_bf16 v57, v24, v24
  v_dot2c_f32_bf16 v56, v25, v59
  v_dot2c_f32_bf16 v57, v25, v25
  v_dot2c_f32_bf16 v56, v26, v59
  v_dot2c_f32_bf16 v57, v26, v26
  v_dot2c_f32_bf16 v56, v27, v59
  v_dot2c_f32_bf16 v57, v27, v27
  s_nop 2
  v_add_f32_dpp v56, v56, v56 row_ror:1 row_mask:0xf bank_mask:0xf
  v_add_f32_dpp v57, v57, v57 row_ror:1 row_mask:0xf bank_mask:0xf
  s_nop 0
  v_add_f32_dpp v56, v56, v56 row_ror:2 row_mask:0xf bank_mask:0xf
  v_add_f32_dpp v57, v57, v57 row_ror:2 row_mask:0xf bank_mask:0xf
  s_nop 0
  v_add_f32_dpp v56, v56, v56 row_ror:4 row_mask:0xf bank_mask:0xf
  v_add_f32_dpp v57, v57, v57 row_ror:4 row_mask:0xf bank_mask:0xf
  s_nop 0
  v_add_f32_dpp v56, v56, v56 row_ror:8 row_mask:0xf bank_mask:0xf
  v_add_f32_dpp v57, v57, v57 row_ror:8 row_mask:0xf bank_mask:0xf
  v_mov_b32 v60, v56
  v_mov_b32 v61, v57
  s_nop 0
  v_permlane16_swap_b32 v56, v60
  v_permlane16_swap_b32 v57, v61
  v_add_f32 v56, v56, v60
  v_add_f32 v57, v57, v61
  v_mul_f32 v56, 989855744, v56
  v_mov_b32 v60, 925353388
  v_fmac_f32 v60, 989855744, v57
  v_fma_f32 v60, -v56, v56, v60
  v_max_f32 v60, 925353388, v60
  v_rsq_f32 v57, v60
  v_lshlrev_b32 v28, 16, v28
  v_sub_f32 v28, v28, v56
  v_mul_f32 v28, v28, v57
  v_lshlrev_b32 v60, 2, v1
  ds_write_b32 v60, v28 offset:13056
  s_nop 0
L_B_noln:
  s_waitcnt vmcnt(4)
  v_perm_b32 v96, v68, v64, s86
  v_perm_b32 v100, v68, v64, s87
  v_perm_b32 v97, v76, v72, s86
  v_perm_b32 v101, v76, v72, s87
  v_perm_b32 v104, v69, v65, s86
  v_perm_b32 v108, v69, v65, s87
  v_perm_b32 v105, v77, v73, s86
  v_perm_b32 v109, v77, v73, s87
  v_perm_b32 v112, v70, v66, s86
  v_perm_b32 v116, v70, v66, s87
  v_perm_b32 v113, v78, v74, s86
  v_perm_b32 v117, v78, v74, s87
  v_perm_b32 v120, v71, v67, s86
  v_perm_b32 v124, v71, v67, s87
  v_perm_b32 v121, v79, v75, s86
  v_perm_b32 v125, v79, v75, s87
  s_waitcnt vmcnt(1)
  s_sub_u32 s64, s6, 1
  s_cmp_lt_u32 s64, 1
  s_cbranch_scc1 L_B_w1
  s_waitcnt vmcnt(0)
L_B_w1:
  v_perm_b32 v98, v84, v80, s86
  v_perm_b32 v102, v84, v80, s87
  v_perm_b32 v99, v92, v88, s86
  v_perm_b32 v103, v92, v88, s87
  v_perm_b32 v106, v85, v81, s86
  v_perm_b32 v110, v85, v81, s87
  v_perm_b32 v107, v93, v89, s86
  v_perm_b32 v111, v93, v89, s87
  v_perm_b32 v114, v86, v82, s86
  v_perm_b32 v118, v86, v82, s87
  v_perm_b32 v115, v94, v90, s86
  v_perm_b32 v119, v94, v90, s87
  v_perm_b32 v122, v87, v83, s86
  v_perm_b32 v126, v87, v83, s87
  v_perm_b32 v123, v95, v91, s86
  v_perm_b32 v127, v95, v91, s87
  s_waitcnt lgkmcnt(0)
  v_mfma_f32_16x16x32_bf16 v[16:19], v[48:51], v[96:99], 0
  v_mfma_f32_16x16x32_bf16 v[20:23], v[48:51], v[100:103], 0
  v_mfma_f32_16x16x32_bf16 v[24:27], v[48:51], v[104:107], 0
  v_mfma_f32_16x16x32_bf16 v[28:31], v[48:51], v[108:111], 0
  v_mfma_f32_16x16x32_bf16 v[32:35], v[48:51], v[112:115], 0
  v_mfma_f32_16x16x32_bf16 v[36:39], v[48:51], v[116:119], 0
  v_mfma_f32_16x16x32_bf16 v[40:43], v[48:51], v[120:123], 0
  v_mfma_f32_16x16x32_bf16 v[44:47], v[48:51], v[124:127], 0
  s_mov_b32 exec_lo, 0xff0000ff
  s_mov_b32 exec_hi, 0
  ds_write2_b64 v14, v[16:17], v[20:21] offset0:0 offset1:1
  s_nop 0
  ds_write2_b64 v14, v[24:25], v[28:29] offset0:2 offset1:3
  s_nop 0
  ds_write2_b64 v14, v[32:33], v[36:37] offset0:4 offset1:5
  s_nop 0
  ds_write2_b64 v14, v[40:41], v[44:45] offset0:6 offset1:7
  s_mov_b64 exec, -1
  ds_add_u32 v15, v3 offset:26112
  s_cmp_lg_u32 s6, 1
  s_cbranch_scc1 L_B_noeps
  s_waitcnt vmcnt(0)
L_ep_9:
  v_readfirstlane_b32 s64, v61
  s_cmp_lg_u32 s64, 0
  s_nop 2
  s_cbranch_scc1 L_B_epok
  s_mov_b64 exec, 1
  buffer_load_dword v61, v2, s[56:59], 0 offen offset:128 sc1
  s_mov_b64 exec, -1
  s_waitcnt vmcnt(0)
  s_sub_u32 s7, s7, 1
  s_cbranch_scc0 L_ep_9
  s_branch L_exit
L_B_epok:
  s_mov_b64 exec, 1
  ds_write_b32 v2, v61 offset:20096
  ds_add_u32 v2, v3 offset:26200
  s_getreg_b32 s64, hwreg(HW_REG_XCC_ID)
  v_mov_b32 v56, s64
  v_mov_b32 v57, s64
  v_mov_b32 v58, v61
  v_not_b32 v59, v61
  s_lshl_b32 s64, s4, 8
  s_lshl_b32 s65, s91, 4
  s_add_u32 s64, s64, s65
  s_add_u32 s64, s64, 49152
  buffer_store_dwordx4 v[56:59], v2, s[8:11], s64 offen sc1
  s_lshl_b32 s64, s29, 13
  s_lshl_b32 s65, s28, 7
  s_add_u32 s64, s64, s65
  s_add_u32 s64, s64, 1835008
  s_mov_b64 exec, 15
  v_readfirstlane_b32 s65, v61
  v_lshlrev_b32 v60, 11, v1
  s_nop 0
  v_mov_b32 v62, s65
  buffer_store_dword v62, v60, s[8:11], s64 offen sc1
  s_mov_b64 exec, -1
L_B_noeps:
  buffer_load_dwordx4 v[224:227], v182, s[12:15], s66 offen offset:0
  buffer_load_dwordx4 v[228:231], v182, s[12:15], s66 offen offset:64
  buffer_load_dwordx4 v[232:235], v182, s[12:15], s66 offen offset:128
  buffer_load_dwordx4 v[236:239], v182, s[12:15], s66 offen offset:192
  s_add_u32 s66, s66, 32768
  buffer_load_dwordx4 v[240:243], v182, s[12:15], s66 offen offset:0
  buffer_load_dwordx4 v[244:247], v182, s[12:15], s66 offen offset:64
  buffer_load_dwordx4 v[248:251], v182, s[12:15], s66 offen offset:128
  buffer_load_dwordx4 v[252:255], v182, s[12:15], s66 offen offset:192
  v_and_b32 v14, 1, v6
  v_lshlrev_b32 v5, 15, v14
  v_lshl_add_u32 v5, v7, 4, v5
  v_lshlrev_b32 v180, 12, v14
  v_lshl_add_u32 v180, v13, 2, v180
  s_lshl_b32 s65, s90, 2
  s_add_u32 s65, s65, s6
  s_lshl_b32 s63, s46, 4
  s_add_u32 s65, s65, s63
  s_lshl_b32 s63, s65, 6
  s_add_u32 s63, s63, 65536
  s_lshl_b32 s62, s65, 3
  s_add_u32 s62, s62, 131072
  s_lshl_b32 s65, s6, 1
  v_add_u32 v179, s65, v1
  v_mul_u32_u24 v178, 17, v179
  v_add_u32 v178, s47, v178
  v_and_b32 v178, 127, v178
  v_lshlrev_b32 v178, 7, v178
  v_lshl_add_u32 v178, v179, 2, v178
  v_add_u32 v178, 32768, v178
  s_lshl_b32 s61, s46, 14
  s_lshl_b32 s64, s6, 12
  s_add_u32 s61, s61, s64
  s_add_u32 s61, s61, 1277952
  v_lshrrev_b32 v183, 5, v1
  s_lshl_b32 s64, s6, 1
  v_add_u32 v183, s64, v183
  v_mul_u32_u24 v183, 272, v183
  v_and_b32 v14, 31, v1
  v_lshl_add_u32 v183, v14, 3, v183
  v_and_b32 v181, 7, v6
  v_mul_u32_u24 v181, 272, v181
  v_lshl_add_u32 v181, v7, 4, v181
  s_movk_i32 s54, 0x3f80
  s_mov_b32 s55, 0x3f800000
  v_mov_b32 v16, 0
  v_mov_b32 v17, 0
  v_mov_b32 v18, 0
  v_mov_b32 v19, 0
  s_lshl_b32 s61, s46, 14
  s_lshl_b32 s64, s3, 11
  s_add_u32 s61, s61, s64
  s_add_u32 s61, s61, 1277952
  v_lshrrev_b32 v183, 5, v1
  s_lshl_b32 s64, s3, 1
  v_add_u32 v183, s64, v183
  v_mul_u32_u24 v183, 272, v183
  v_and_b32 v14, 31, v1
  v_lshl_add_u32 v183, v14, 3, v183
  s_movk_i32 s54, 0x3f80
  s_mov_b32 s55, 0x3f800000
  v_mov_b32 v16, 0
  v_mov_b32 v17, 0
  v_mov_b32 v18, 0
  v_mov_b32 v19, 0
  v_mul_u32_u24 v181, 272, v6
  v_lshl_add_u32 v181, v7, 4, v181
  s_nop 1
L_wc_10:
  ds_read_b32 v4, v2 offset:26200
  ds_read_b32 v186, v2 offset:20096
  s_waitcnt lgkmcnt(0)
  v_readfirstlane_b32 s68, v4
  s_cmp_ge_u32 s68, 1
  s_nop 2
  s_cbranch_scc1 L_wcd_11
  s_sub_u32 s7, s7, 1
  s_cbranch_scc0 L_wc_10
  s_branch L_exit
L_wcd_11:
  v_mov_b32 v187, v186
  s_mov_b32 exec_lo, 0
  v_not_b32 v187, v186
  s_mov_b32 exec_lo, -1
  v_readfirstlane_b32 s88, v186
  s_not_b32 s89, s88
  s_lshl_b32 s65, s46, 11
  s_lshl_b32 s64, s3, 8
  s_add_u32 s65, s65, s64
  s_add_u32 s65, s65, 1835008
  v_lshlrev_b32 v137, 7, v1
  s_mov_b64 s[70:71], 0
  s_mov_b64 s[72:73], 0
  s_mov_b64 s[74:75], 3
  s_mov_b32 s76, 0
  v_mov_b32 v130, 0
  v_mov_b32 v134, 0
  s_nop 1
L_wc_12:
  ds_read_b32 v4, v2 offset:26120
  s_waitcnt lgkmcnt(0)
  v_readfirstlane_b32 s68, v4
  s_cmp_ge_u32 s68, 4
  s_nop 2
  s_cbranch_scc1 L_wcd_13
  s_sleep 1
  s_sub_u32 s7, s7, 1
  s_cbranch_scc0 L_wc_12
  s_branch L_exit
L_wcd_13:
L_qq_14:
  s_mov_b64 exec, s[70:71]
  buffer_load_dwordx4 v[128:131], v8, s[8:11], s61 offen sc1
  s_mov_b64 exec, s[72:73]
  buffer_load_dwordx4 v[132:135], v8, s[8:11], s61 offen offset:1024 sc1
  s_mov_b64 exec, s[74:75]
  buffer_load_dword v136, v137, s[8:11], s65 offen sc1
  s_waitcnt vmcnt(0)
L_qq_14_c:
  v_cmp_ne_u32_e64 s[74:75], s88, v136
  s_mov_b64 exec, -1
  v_cmp_ne_u64_e64 s[70:71], s[88:89], v[130:131]
  v_cmp_ne_u64_e64 s[72:73], s[88:89], v[134:135]
  s_or_b64 s[68:69], s[70:71], s[72:73]
  s_nop 2
  s_cbranch_scc0 L_qqd_15
  s_bitcmp1_b32 s74, 0
  s_cselect_b64 s[70:71], 0, s[70:71]
  s_bitcmp1_b32 s74, 1
  s_cselect_b64 s[72:73], 0, s[72:73]
  s_sub_u32 s7, s7, 1
  s_cbranch_scc0 L_qq_14
  s_branch L_exit
L_qqd_15:
  v_dot2c_f32_bf16 v16, s54, v128
  v_dot2c_f32_bf16 v17, s55, v128
  v_dot2c_f32_bf16 v18, s54, v129
  v_dot2c_f32_bf16 v19, s55, v129
  v_dot2c_f32_bf16 v16, s54, v132
  v_dot2c_f32_bf16 v17, s55, v132
  v_dot2c_f32_bf16 v18, s54, v133
  v_dot2c_f32_bf16 v19, s55, v133
  s_nop 1
  v_cvt_pk_bf16_f32 v20, v16, v17
  s_nop 0
  v_cvt_pk_bf16_f32 v21, v18, v19
  ds_write_b64 v183, v[20:21] offset:13312
  ds_add_u32 v15, v3 offset:26204
L_wc_16:
  ds_read_b32 v4, v2 offset:26204
  ds_read_b128 v[64:67], v181 offset:13312
  ds_read_b128 v[72:75], v181 offset:13376
  ds_read_b128 v[80:83], v181 offset:13440
  ds_read_b128 v[88:91], v181 offset:13504
  s_waitcnt lgkmcnt(0)
  v_readfirstlane_b32 s68, v4
  s_cmp_ge_u32 s68, 8
  s_nop 2
  s_cbranch_scc1 L_wcd_17
  s_sub_u32 s7, s7, 1
  s_cbranch_scc0 L_wc_16
  s_branch L_exit
L_wcd_17:
  v_mfma_f32_16x16x32_bf16 v[16:19], v[224:227], v[64:67], 0
  v_mfma_f32_16x16x32_bf16 v[20:23], v[240:243], v[64:67], 0
  v_mfma_f32_16x16x32_bf16 v[16:19], v[228:231], v[72:75], v[16:19]
  v_mfma_f32_16x16x32_bf16 v[20:23], v[244:247], v[72:75], v[20:23]
  v_mfma_f32_16x16x32_bf16 v[16:19], v[232:235], v[80:83], v[16:19]
  v_mfma_f32_16x16x32_bf16 v[20:23], v[248:251], v[80:83], v[20:23]
  v_mfma_f32_16x16x32_bf16 v[16:19], v[236:239], v[88:91], v[16:19]
  v_mfma_f32_16x16x32_bf16 v[20:23], v[252:255], v[88:91], v[20:23]
  s_nop 6
  v_add_f32_dpp v16, v16, v16 quad_perm:[2,3,0,1] row_mask:0xf bank_mask:0xf
  v_add_f32_dpp v17, v17, v17 quad_perm:[2,3,0,1] row_mask:0xf bank_mask:0xf
  v_add_f32_dpp v18, v18, v18 quad_perm:[2,3,0,1] row_mask:0xf bank_mask:0xf
  v_add_f32_dpp v19, v19, v19 quad_perm:[2,3,0,1] row_mask:0xf bank_mask:0xf
  v_add_f32_dpp v20, v20, v20 quad_perm:[2,3,0,1] row_mask:0xf bank_mask:0xf
  v_add_f32_dpp v21, v21, v21 quad_perm:[2,3,0,1] row_mask:0xf bank_mask:0xf
  v_add_f32_dpp v22, v22, v22 quad_perm:[2,3,0,1] row_mask:0xf bank_mask:0xf
  v_add_f32_dpp v23, v23, v23 quad_perm:[2,3,0,1] row_mask:0xf bank_mask:0xf
  v_add_f32_dpp v16, v16, v16 row_shl:8 row_mask:0xf bank_mask:0x3
  v_add_f32_dpp v17, v17, v17 row_shl:8 row_mask:0xf bank_mask:0x3
  v_add_f32_dpp v18, v18, v18 row_shl:8 row_mask:0xf bank_mask:0x3
  v_add_f32_dpp v19, v19, v19 row_shl:8 row_mask:0xf bank_mask:0x3
  v_add_f32_dpp v20, v20, v20 row_shl:8 row_mask:0xf bank_mask:0x3
  v_add_f32_dpp v21, v21, v21 row_shl:8 row_mask:0xf bank_mask:0x3
  v_add_f32_dpp v22, v22, v22 row_shl:8 row_mask:0xf bank_mask:0x3
  v_add_f32_dpp v23, v23, v23 row_shl:8 row_mask:0xf bank_mask:0x3
  v_add_f32_dpp v16, v16, v16 row_shl:4 row_mask:0xf bank_mask:0x1
  v_add_f32_dpp v17, v17, v17 row_shl:4 row_mask:0xf bank_mask:0x1
  v_add_f32_dpp v18, v18, v18 row_shl:4 row_mask:0xf bank_mask:0x1
  v_add_f32_dpp v19, v19, v19 row_shl:4 row_mask:0xf bank_mask:0x1
  v_add_f32_dpp v20, v20, v20 row_shl:4 row_mask:0xf bank_mask:0x1
  v_add_f32_dpp v21, v21, v21 row_shl:4 row_mask:0xf bank_mask:0x1
  v_add_f32_dpp v22, v22, v22 row_shl:4 row_mask:0xf bank_mask:0x1
  v_add_f32_dpp v23, v23, v23 row_shl:4 row_mask:0xf bank_mask:0x1
  v_cvt_pk_bf16_f32 v24, v16, v17
  v_cvt_pk_bf16_f32 v25, v18, v19
  v_cvt_pk_bf16_f32 v26, v20, v21
  v_cvt_pk_bf16_f32 v27, v22, v23
  s_mov_b32 exec_lo, 0x00030003
  s_mov_b32 exec_hi, 0x00030003
  buffer_store_dwordx4 v[24:27], v5, s[8:11], s63 offen sc1
  s_mov_b64 exec, -1
  v_xor_b32 v28, v24, v26
  v_xor_b32 v29, v25, v27
  s_nop 1
  v_permlane32_swap_b32 v28, v29
  v_xor_b32 v28, v28, v29
  v_mov_b32 v29, v28
  s_nop 1
  v_permlane16_swap_b32 v28, v29
  v_bitop3_b32 v28, v28, v29, v187 bitop3:0x96
  s_mov_b32 exec_lo, 3
  s_mov_b32 exec_hi, 3
  buffer_store_dword v28, v180, s[8:11], s62 offen sc1
  s_mov_b64 exec, -1
  s_setprio 0
  s_mov_b64 exec, 3
  buffer_store_dword v186, v178, s[8:11], 0 offen sc1
  s_mov_b64 exec, -1
  ds_add_u32 v15, v3 offset:26172
L_V:
  s_mov_b32 s12, s26
  s_mov_b32 s13, s27
  s_mov_b32 s14, 4194304
  s_mov_b32 s15, 0x00020000
  s_mov_b32 s48, s24
  s_mov_b32 s49, s25
  s_mov_b32 s50, 4194304
  s_mov_b32 s51, 0x00020000
  v_lshlrev_b32 v9, 17, v7
  v_lshl_add_u32 v9, v6, 4, v9
  s_and_b32 s29, s90, 2
  s_lshl_b32 s29, s29, 1
  s_xor_b32 s29, s29, s3
  s_and_b32 s64, s90, 1
  s_lshl_b32 s64, s64, 1
  s_lshr_b32 s65, s29, 2
  s_add_u32 s64, s64, s65
  s_lshl_b32 s64, s64, 7
  s_lshl_b32 s65, s6, 2
  s_add_u32 s64, s64, s65
  s_lshl_b32 s64, s64, 13
  s_lshl_b32 s65, s46, 8
  s_add_u32 s64, s64, s65
  s_cmp_lg_u32 s3, 5
  s_cbranch_scc1 L_noxt0
  s_lshl_b32 s65, s4, 8
  s_add_u32 s65, s65, 49152
  s_mov_b64 exec, 0xffff
  buffer_load_dwordx4 v[132:135], v8, s[8:11], s65 offen sc1
  s_mov_b64 exec, -1
L_noxt0:
  s_cmp_lg_u32 s3, 1
  s_cbranch_scc1 L_noslo
  s_lshr_b32 s65, s91, 2
  s_lshl_b32 s65, s65, 3
  s_add_u32 s65, s65, s4
  s_lshl_b32 s65, s65, 17
  s_and_b32 s66, s91, 3
  s_lshl_b32 s66, s66, 15
  s_add_u32 s65, s65, s66
  v_lshlrev_b32 v136, 10, v1
  s_mov_b32 exec_hi, 0
  buffer_load_dword v137, v136, s[12:15], s65 offen offset:384
  s_mov_b32 exec_hi, -1
L_noslo:
  s_add_u32 s65, s64, 0
  buffer_load_dwordx4 v[100:103], v9, s[48:51], s65 offen
  s_add_u32 s65, s64, 8192
  buffer_load_dwordx4 v[104:107], v9, s[48:51], s65 offen
  s_add_u32 s65, s64, 16384
  buffer_load_dwordx4 v[108:111], v9, s[48:51], s65 offen
  s_add_u32 s65, s64, 24576
  buffer_load_dwordx4 v[112:115], v9, s[48:51], s65 offen
  s_add_u32 s65, s64, 524288
  buffer_load_dwordx4 v[116:119], v9, s[48:51], s65 offen
  s_add_u32 s65, s64, 532480
  buffer_load_dwordx4 v[120:123], v9, s[48:51], s65 offen
  s_add_u32 s65, s64, 540672
  buffer_load_dwordx4 v[124:127], v9, s[48:51], s65 offen
  s_add_u32 s65, s64, 548864
  buffer_load_dwordx4 v[128:131], v9, s[48:51], s65 offen
  s_mov_b64 exec, -1
  v_lshrrev_b32 v11, 2, v6
  v_lshl_add_u32 v9, v11, 2, v7
  v_lshlrev_b32 v9, 12, v9
  v_and_b32 v11, 3, v6
  v_lshl_add_u32 v9, v11, 4, v9
  s_and_b32 s79, s91, 0
  s_lshl_b32 s79, s79, 2
  s_xor_b32 s79, s79, s3
  s_lshr_b32 s64, s79, 1
  s_lshl_b32 s64, s64, 3
  s_add_u32 s64, s64, s4
  s_lshl_b32 s64, s64, 1
  s_and_b32 s65, s3, 1
  s_add_u32 s64, s64, s65
  s_lshl_b32 s64, s64, 16
  s_lshl_b32 s65, s91, 6
  s_add_u32 s64, s64, s65
  s_mov_b32 s78, s64
  v_lshlrev_b32 v11, 10, v1
  s_bitcmp1_b32 s91, 0
  s_cselect_b32 exec_lo, 0, 4294967295
  s_cselect_b32 exec_hi, 4294967295, 0
  buffer_load_dword v136, v11, s[12:15], s64 offen
  s_mov_b64 exec, -1
  s_cmp_eq_u32 s93, 0
  s_cbranch_scc1 L_mod_done
  s_lshl_b32 s64, s6, 10
  s_add_u32 s64, s64, 26368
  v_lshl_add_u32 v14, v6, 6, s64
  v_lshlrev_b32 v61, 2, v1
  v_lshlrev_b32 v62, 3, v1
  v_add_u32 v62, 26368, v62
  s_and_b32 s60, s28, 3
  s_lshl_b32 s60, s60, 14
  s_lshl_b32 s64, s95, 8
  s_add_u32 s60, s60, s64
  s_add_u32 s60, s60, 1179648
  s_add_u32 s61, s60, 8192
  v_mov_b32 v54, s88
  v_mov_b32 v55, s89
  s_waitcnt vmcnt(9) lgkmcnt(0)
  v_perm_b32 v224, v212, v208, s86
  v_perm_b32 v226, v212, v208, s87
  v_perm_b32 v225, v220, v216, s86
  v_perm_b32 v227, v220, v216, s87
  v_perm_b32 v228, v213, v209, s86
  v_perm_b32 v230, v213, v209, s87
  v_perm_b32 v229, v221, v217, s86
  v_perm_b32 v231, v221, v217, s87
  v_perm_b32 v232, v214, v210, s86
  v_perm_b32 v234, v214, v210, s87
  v_perm_b32 v233, v222, v218, s86
  v_perm_b32 v235, v222, v218, s87
  v_perm_b32 v236, v215, v211, s86
  v_perm_b32 v238, v215, v211, s87
  v_perm_b32 v237, v223, v219, s86
  v_perm_b32 v239, v223, v219, s87
  v_mfma_f32_16x16x16_bf16 v[16:19], v[240:241], v[224:225], 0
  v_mfma_f32_16x16x16_bf16 v[20:23], v[240:241], v[226:227], 0
  v_mfma_f32_16x16x16_bf16 v[24:27], v[240:241], v[228:229], 0
  v_mfma_f32_16x16x16_bf16 v[28:31], v[240:241], v[230:231], 0
  v_mfma_f32_16x16x16_bf16 v[32:35], v[240:241], v[232:233], 0
  v_mfma_f32_16x16x16_bf16 v[36:39], v[240:241], v[234:235], 0
  v_mfma_f32_16x16x16_bf16 v[40:43], v[240:241], v[236:237], 0
  v_mfma_f32_16x16x16_bf16 v[44:47], v[240:241], v[238:239], 0
  s_mov_b32 exec_lo, 0xff0000ff
  s_mov_b32 exec_hi, 0
  s_nop 3
  ds_write2_b64 v14, v[16:17], v[20:21] offset0:0 offset1:1
  ds_write2_b64 v14, v[24:25], v[28:29] offset0:2 offset1:3
  ds_write2_b64 v14, v[32:33], v[36:37] offset0:4 offset1:5
  ds_write2_b64 v14, v[40:41], v[44:45] offset0:6 offset1:7
  s_mov_b64 exec, -1
  ds_add_u32 v15, v3 offset:26168
  s_cmp_lg_u32 s6, 0
  s_cbranch_scc1 L_mod_done
L_wc_18:
  ds_read_b32 v4, v2 offset:26168
  ds_read2st64_b64 v[16:19], v62 offset0:0 offset1:1
  ds_read2st64_b64 v[20:23], v62 offset0:2 offset1:3
  ds_read2st64_b64 v[24:27], v62 offset0:4 offset1:5
  ds_read2st64_b64 v[28:31], v62 offset0:6 offset1:7
  s_waitcnt lgkmcnt(0)
  v_readfirstlane_b32 s68, v4
  s_cmp_ge_u32 s68, 4
  s_nop 2
  s_cbranch_scc1 L_wcd_19
  s_sub_u32 s7, s7, 1
  s_cbranch_scc0 L_wc_18
  s_branch L_exit
L_wcd_19:
  v_pk_add_f32 v[16:17], v[16:17], v[18:19]
  v_pk_add_f32 v[20:21], v[20:21], v[22:23]
  v_pk_add_f32 v[24:25], v[24:25], v[26:27]
  v_pk_add_f32 v[28:29], v[28:29], v[30:31]
  v_pk_add_f32 v[16:17], v[16:17], v[20:21]
  v_pk_add_f32 v[24:25], v[24:25], v[28:29]
  v_pk_add_f32 v[16:17], v[16:17], v[24:25]
  s_nop 1
  v_mov_b32_dpp v18, v16 quad_perm:[1,1,3,3] row_mask:0xf bank_mask:0xf
  v_mov_b32_dpp v19, v17 quad_perm:[1,1,3,3] row_mask:0xf bank_mask:0xf
  v_cvt_pk_bf16_f32 v52, v16, v18
  v_cvt_pk_bf16_f32 v56, v17, v19
  s_nop 0
  v_mov_b32_dpp v53, v52 quad_perm:[2,2,2,2] row_mask:0xf bank_mask:0xf
  v_mov_b32_dpp v57, v56 quad_perm:[2,2,2,2] row_mask:0xf bank_mask:0xf
  s_mov_b32 exec_lo, 0x11111111
  s_mov_b32 exec_hi, 0x11111111
  buffer_store_dwordx4 v[52:55], v61, s[8:11], s60 offen sc1
  buffer_store_dwordx4 v[56:59], v61, s[8:11], s61 offen sc1
  s_mov_b64 exec, -1
  s_nop 0
L_mod_done:
L_V_done:
  s_lshl_b32 s54, s93, 10
  s_add_u32 s54, s54, 67584
  s_lshl_b32 s64, s93, 4
  v_mov_b32 v239, s64
  v_lshrrev_b32 v11, 2, v6
  v_lshl_add_u32 v11, v7, 4, v11
  v_and_b32 v13, 3, v6
  v_mul_u32_u24 v160, 656, v11
  v_lshl_add_u32 v160, v13, 3, v160
  s_mul_i32 s65, s29, 80
  s_add_u32 s65, s65, 42752
  v_add_u32 v160, s65, v160
  v_lshlrev_b32 v161, 3, v1
  v_add_u32 v161, 84736, v161
  s_lshl_b32 s65, s3, 8
  s_add_u32 s65, s65, 85248
  v_lshl_add_u32 v162, v1, 1, s65
  v_lshl_add_u32 v163, v7, 4, s65
  s_mul_i32 s65, s3, 272
  v_lshl_add_u32 v166, v6, 4, s65
  v_lshrrev_b32 v11, 2, v6
  v_mul_u32_u24 v168, 272, v11
  v_lshl_add_u32 v168, v13, 3, v168
  s_lshl_b32 s65, s3, 5
  v_add_u32 v168, s65, v168
  v_lshl_add_u32 v169, v11, 2, v7
  v_lshlrev_b32 v169, 4, v169
  v_lshl_add_u32 v169, v13, 9, v169
  v_lshl_add_u32 v170, v7, 2, v6
  v_lshlrev_b32 v170, 4, v170
  s_lshl_b32 s65, s3, 8
  s_add_u32 s65, s65, 87296
  v_add_u32 v170, s65, v170
  v_lshrrev_b32 v170, 3, v1
  v_lshlrev_b32 v170, 6, v170
  v_lshl_add_u32 v170, v13, 4, v170
  v_add_u32 v170, s65, v170
  v_and_b32 v12, 0x24, v1
  v_cmp_eq_u32 vcc, 0, v12
  v_mov_b32 v12, 0x7ff00000
  s_nop 0
  v_cndmask_b32 v170, v12, v170, vcc
  v_lshlrev_b32 v171, 2, v1
  v_add_u32 v171, 87296, v171
  v_mov_b32 v96, 0x3f803f80
  v_cmp_gt_u32 vcc, 16, v1
  s_nop 1
  v_cndmask_b32 v96, 0, v96, vcc
  v_mov_b32 v97, v96
  v_mov_b32 v98, v96
  v_mov_b32 v99, v96
  v_lshrrev_b32 v11, 3, v0
  v_and_b32 v12, 7, v0
  v_lshlrev_b32 v172, 9, v11
  v_lshl_add_u32 v172, v12, 4, v172
  v_and_b32 v14, 4, v0
  v_lshlrev_b32 v175, 3, v0
  v_mul_u32_u24 v173, 656, v11
  v_mul_u32_u24 v12, 80, v13
  v_lshl_add_u32 v12, v14, 2, v12
  s_mov_b32 s65, 42752
  v_add3_u32 v173, v173, v12, s65
  v_lshlrev_b32 v167, 3, v11
  v_lshl_add_u32 v167, v13, 1, v167
  v_add_u32 v167, 84736, v167
  s_lshl_b32 s64, s46, 2
  s_add_u32 s64, s64, s90
  s_mul_i32 s53, s64, 36864
  s_add_u32 s53, s53, 2097152
  s_add_u32 s55, s53, 32768
  s_lshl_b32 s64, s4, 13
  s_add_u32 s64, s64, 196608
  s_and_b32 s65, s91, 3
  s_lshl_b32 s65, s65, 2
  s_add_u32 s65, s65, s90
  s_lshl_b32 s52, s65, 9
  s_add_u32 s52, s52, s64
  s_lshl_b32 s65, s3, 6
  s_add_u32 s52, s52, s65
  s_lshr_b32 s65, s79, 1
  s_lshl_b32 s65, s65, 11
  s_add_u32 s60, s64, s65
  s_and_b32 s65, s3, 1
  s_lshl_b32 s65, s65, 8
  s_add_u32 s60, s60, s65
  s_lshl_b32 s61, s4, 12
  s_lshl_b32 s65, s91, 7
  s_add_u32 s61, s61, s65
  s_add_u32 s61, s61, 262144
  v_bfe_u32 v174, v1, 2, 2
  v_lshlrev_b32 v174, 5, v174
  v_and_b32 v12, 1, v7
  v_lshl_add_u32 v174, v12, 4, v174
  v_lshrrev_b32 v12, 5, v1
  v_lshl_add_u32 v174, v12, 11, v174
  v_cmp_eq_u32 vcc, 0, v13
  v_mov_b32 v12, 0x7ff00000
  s_nop 0
  v_cndmask_b32 v174, v12, v174, vcc
  v_mul_u32_u24 v164, 17, v1
  v_add_u32 v164, s47, v164
  v_and_b32 v164, 127, v164
  v_lshlrev_b32 v164, 7, v164
  v_lshl_add_u32 v164, v1, 2, v164
  v_add_u32 v164, 16384, v164
  v_mov_b32 v12, 0x7ff00000
  v_and_b32 v165, 7, v1
  v_cmp_eq_u32 vcc, 0, v165
  s_nop 1
  v_cndmask_b32 v165, v12, v2, vcc
  v_and_b32 v164, 5, v1
  v_cmp_eq_u32 vcc, 0, v164
  s_nop 1
  v_cndmask_b32 v167, v12, v167, vcc
  v_cmp_eq_u32 vcc, 0, v6
  s_nop 1
  v_cndmask_b32 v164, v12, v1, vcc
  v_cmp_gt_u32 vcc, 16, v1
  s_nop 1
  v_cndmask_b32 v166, v12, v166, vcc
  s_mul_i32 s65, s3, 96
  v_lshl_add_u32 v168, v7, 5, v168
  v_add_u32 v168, s65, v168
  s_mul_i32 s65, s3, 192
  s_add_u32 s52, s52, s65
  v_lshlrev_b32 v164, 6, v6
  v_lshl_add_u32 v164, v7, 4, v164
  v_cmp_gt_u32 vcc, 4, v6
  s_nop 1
  v_cndmask_b32 v164, v12, v164, vcc
  v_mov_b32 v96, 0x3f803f80
  v_cmp_eq_u32 vcc, v6, v7
  s_nop 1
  v_cndmask_b32 v96, 0, v96, vcc
  v_mov_b32 v97, v96
  v_mov_b32 v98, v96
  v_mov_b32 v99, v96
  v_mov_b32 v234, s88
  v_mov_b32 v235, s89
  s_cmp_lg_u32 s3, 5
  s_cbranch_scc1 L_noxt
  s_lshl_b32 s64, s4, 8
  s_add_u32 s64, s64, 49152
  s_mov_b64 exec, 0xffff
  s_waitcnt vmcnt(9)
  v_cmp_ne_u64 vcc, s[88:89], v[134:135]
  s_nop 0
  s_cbranch_vccz L_xtok
  buffer_load_dwordx4 v[132:135], v8, s[8:11], s64 offen sc1
L_pp_20:
  s_waitcnt vmcnt(0)
  v_cmp_ne_u64_e64 vcc, s[88:89], v[134:135]
  s_nop 0
  s_cbranch_vccz L_ppd_22
  s_sleep 2
  buffer_load_dwordx4 v[132:135], v8, s[8:11], s64 offen sc1
  s_sub_u32 s7, s7, 1
  s_cbranch_scc0 L_pp_20
  s_branch L_exit
L_ppd_22:
L_ppe_21:
L_xtok:
  s_getreg_b32 s64, hwreg(HW_REG_XCC_ID)
  v_cmp_ne_u32 vcc, s64, v132
  s_mov_b64 exec, -1
  s_nop 0
  v_mov_b32 v48, vcc_lo
  ds_write_b32 v2, v48 offset:20100
  s_nop 0
L_noxt:
  buffer_load_dwordx4 v[48:51], v169, s[8:11], s60 offen sc1
  s_cmp_lg_u32 s3, 4
  s_cbranch_scc1 L_psn_24
  s_lshl_b32 s64, s47, 7
  s_add_u32 s64, s64, 0
  v_lshlrev_b32 v46, 2, v1
  s_mov_b64 exec, 0xff
  s_lshl_b32 s65, s4, 8
  s_add_u32 s65, s65, 53248
  s_bitcmp1_b32 s46, 4
  s_cselect_b32 s66, 0, 2048
  s_add_u32 s65, s65, s66
  s_mov_b32 s66, 0
L_nh_26:
  s_mov_b64 exec, -1
  buffer_load_dword v208, v46, s[8:11], s65 offen sc1
  s_waitcnt vmcnt(0)
  v_cmp_ne_u32 vcc, s88, v208
  s_bcnt1_i32_b64 s67, vcc
  s_cmp_le_u32 s67, 12
  s_cbranch_scc1 L_nhd_27
  s_add_u32 s66, s66, 1
  s_and_b32 s67, s66, 15
  s_cbranch_scc1 L_nh_26
  s_mov_b64 exec, 0xff
  buffer_load_dword v208, v46, s[8:11], s64 offen sc1
  s_waitcnt vmcnt(0)
  v_cmp_ne_u32 vcc, s88, v208
  s_nop 0
  s_cbranch_vccz L_nhd_27
  s_sub_u32 s7, s7, 1
  s_cbranch_scc0 L_nh_26
  s_branch L_exit
L_nhd_27:
  s_mov_b64 exec, -1
L_psn_24:
  s_barrier
  buffer_load_dwordx4 v[16:19], v172, s[8:11], s53 offen offset:0 sc1
  buffer_load_dwordx4 v[20:23], v172, s[8:11], s53 offen offset:128 sc1
  buffer_load_dwordx4 v[24:27], v172, s[8:11], s53 offen offset:256 sc1
  buffer_load_dwordx4 v[28:31], v172, s[8:11], s53 offen offset:384 sc1
  buffer_load_dwordx2 v[32:33], v175, s[8:11], s55 offen sc1
  s_waitcnt vmcnt(7)
  v_perm_b32 v176, v104, v100, s86
  v_perm_b32 v180, v104, v100, s87
  v_perm_b32 v177, v112, v108, s86
  v_perm_b32 v181, v112, v108, s87
  v_perm_b32 v178, v120, v116, s86
  v_perm_b32 v182, v120, v116, s87
  v_perm_b32 v179, v128, v124, s86
  v_perm_b32 v183, v128, v124, s87
  v_perm_b32 v184, v105, v101, s86
  v_perm_b32 v188, v105, v101, s87
  v_perm_b32 v185, v113, v109, s86
  v_perm_b32 v189, v113, v109, s87
  v_perm_b32 v186, v121, v117, s86
  v_perm_b32 v190, v121, v117, s87
  v_perm_b32 v187, v129, v125, s86
  v_perm_b32 v191, v129, v125, s87
  v_perm_b32 v192, v106, v102, s86
  v_perm_b32 v196, v106, v102, s87
  v_perm_b32 v193, v114, v110, s86
  v_perm_b32 v197, v114, v110, s87
  v_perm_b32 v194, v122, v118, s86
  v_perm_b32 v198, v122, v118, s87
  v_perm_b32 v195, v130, v126, s86
  v_perm_b32 v199, v130, v126, s87
  v_perm_b32 v200, v107, v103, s86
  v_perm_b32 v204, v107, v103, s87
  v_perm_b32 v201, v115, v111, s86
  v_perm_b32 v205, v115, v111, s87
  v_perm_b32 v202, v123, v119, s86
  v_perm_b32 v206, v123, v119, s87
  v_perm_b32 v203, v131, v127, s86
  v_perm_b32 v207, v131, v127, s87
  s_nop 0
  s_branch L_ct_fast
L_pr_28:
  buffer_load_dwordx4 v[16:19], v172, s[8:11], s53 offen offset:0 sc1
  buffer_load_dwordx4 v[20:23], v172, s[8:11], s53 offen offset:128 sc1
  buffer_load_dwordx4 v[24:27], v172, s[8:11], s53 offen offset:256 sc1
  buffer_load_dwordx4 v[28:31], v172, s[8:11], s53 offen offset:384 sc1
  buffer_load_dwordx2 v[32:33], v175, s[8:11], s55 offen sc1
  s_waitcnt vmcnt(0)
L_pr_28_w:
  ds_write_b128 v173, v[16:19] offset:0
  ds_write_b128 v173, v[20:23] offset:32
  ds_write_b128 v173, v[24:27] offset:320
  ds_write_b128 v173, v[28:31] offset:352
  v_bitop3_b32 v40, v16, v18, v20 bitop3:0x96
  v_bitop3_b32 v41, v17, v19, v21 bitop3:0x96
  v_bitop3_b32 v42, v22, v24, v26 bitop3:0x96
  v_bitop3_b32 v43, v23, v25, v27 bitop3:0x96
  s_nop 1
L_pr_28_p:
  v_bitop3_b32 v44, v28, v30, v32 bitop3:0x96
  v_bitop3_b32 v45, v29, v31, v33 bitop3:0x96
  v_bitop3_b32 v41, v41, v43, v45 bitop3:0x96
  v_bitop3_b32 v40, v40, v42, v44 bitop3:0x96
  s_nop 0
  v_xor_b32_dpp v41, v41, v41 quad_perm:[1,0,3,2] row_mask:0xf bank_mask:0xf
  v_cmp_ne_u64 vcc, s[88:89], v[40:41]
  s_nop 1
L_ct_slow:
  s_wqm_b64 exec, vcc
  s_cbranch_execz L_pd_30
  s_bcnt1_i32_b64 s67, exec
  s_cmp_le_u32 s67, 16
  s_cbranch_scc1 L_pn_29
  s_sleep 4
L_pn_29:
  s_sub_u32 s7, s7, 1
  s_cbranch_scc0 L_pr_28
  s_branch L_exit
L_pd_30:
  s_mov_b64 exec, -1
  ds_write_b32 v167, v33
  s_branch L_ct_ok
L_ct_fast:
  s_waitcnt vmcnt(4)
  ds_write_b128 v173, v[16:19] offset:0
  s_waitcnt vmcnt(3)
  ds_write_b128 v173, v[20:23] offset:32
  v_bitop3_b32 v40, v16, v18, v20 bitop3:0x96
  v_bitop3_b32 v41, v17, v19, v21 bitop3:0x96
  s_waitcnt vmcnt(2)
  ds_write_b128 v173, v[24:27] offset:320
  v_bitop3_b32 v42, v22, v24, v26 bitop3:0x96
  v_bitop3_b32 v43, v23, v25, v27 bitop3:0x96
  s_waitcnt vmcnt(1)
  ds_write_b128 v173, v[28:31] offset:352
  v_bitop3_b32 v41, v41, v43, v29 bitop3:0x96
  v_bitop3_b32 v40, v40, v42, v28 bitop3:0x96
  s_waitcnt vmcnt(0)
  v_bitop3_b32 v41, v41, v31, v33 bitop3:0x96
  v_bitop3_b32 v40, v40, v30, v32 bitop3:0x96
  ds_write_b32 v167, v33
  v_xor_b32_dpp v41, v41, v41 quad_perm:[1,0,3,2] row_mask:0xf bank_mask:0xf
  v_cmp_ne_u64 vcc, s[88:89], v[40:41]
  s_nop 0
  s_cbranch_vccnz L_ct_slow
L_ct_ok:
  ds_max_u32 v165, v33 offset:26292
  s_waitcnt lgkmcnt(0)
  s_barrier
  buffer_load_dwordx4 v[64:67], v9, s[12:15], s78 offen offset:0
  ds_read_b64 v[40:41], v161
  ds_read_b32 v238, v2 offset:20100
  ds_read_b32 v43, v2 offset:26292
  ds_read_b64_tr_b16 v[16:17], v160 offset:0
  ds_read_b64_tr_b16 v[18:19], v160 offset:2624
  ds_read_b64_tr_b16 v[20:21], v160 offset:32
  ds_read_b64_tr_b16 v[22:23], v160 offset:2656
  ds_read_b64_tr_b16 v[24:25], v160 offset:5248
  ds_read_b64_tr_b16 v[26:27], v160 offset:7872
  ds_read_b64_tr_b16 v[28:29], v160 offset:5280
  ds_read_b64_tr_b16 v[30:31], v160 offset:7904
  buffer_load_dwordx4 v[68:71], v9, s[12:15], s78 offen offset:1024
  s_waitcnt lgkmcnt(8)
  v_sub_u32 v40, v43, v40
  v_min_u32 v40, 0x400, v40
  v_sub_u32 v40, 0, v40
  v_ldexp_f32 v40, 1.0, v40
  s_nop 1
  v_mov_b32_dpp v42, v40 row_shl:1 row_mask:0xf bank_mask:0xf bound_ctrl:0
  v_perm_b32 v44, v42, v40, s87
  s_nop 1
  v_mov_b32_dpp v45, v44 row_shl:2 row_mask:0xf bank_mask:0xf bound_ctrl:0
  v_mov_b32_dpp v46, v44 row_shl:4 row_mask:0xf bank_mask:0xf bound_ctrl:0
  v_mov_b32_dpp v47, v44 row_shl:6 row_mask:0xf bank_mask:0xf bound_ctrl:0
  v_mov_b32_dpp v48, v44 row_shl:8 row_mask:0xf bank_mask:0xf bound_ctrl:0
  v_mov_b32_dpp v49, v44 row_shl:10 row_mask:0xf bank_mask:0xf bound_ctrl:0
  v_mov_b32_dpp v50, v44 row_shl:12 row_mask:0xf bank_mask:0xf bound_ctrl:0
  v_mov_b32_dpp v51, v44 row_shl:14 row_mask:0xf bank_mask:0xf bound_ctrl:0
  v_mul_f32 v237, v40, v41
  buffer_load_dwordx4 v[72:75], v9, s[12:15], s78 offen offset:2048
  s_waitcnt lgkmcnt(4)
  v_mfma_f32_16x16x32_bf16 v[32:35], v[16:19], v[44:47], 0
  v_mfma_f32_16x16x32_bf16 v[36:39], v[20:23], v[44:47], 0
  s_waitcnt lgkmcnt(0)
  v_mfma_f32_16x16x32_bf16 v[32:35], v[24:27], v[48:51], v[32:35]
  v_mfma_f32_16x16x32_bf16 v[36:39], v[28:31], v[48:51], v[36:39]
  buffer_load_dwordx4 v[76:79], v9, s[12:15], s78 offen offset:3072
  s_nop 5
  v_cvt_pk_bf16_f32 v60, v32, v33
  v_cvt_pk_bf16_f32 v61, v34, v35
  v_cvt_pk_bf16_f32 v62, v36, v37
  v_cvt_pk_bf16_f32 v63, v38, v39
  s_nop 1
  v_mfma_f32_16x16x32_bf16 v[16:19], v[60:63], v[176:179], 0
  v_add_f32_dpp v237, v237, v237 row_ror:1 row_mask:0xf bank_mask:0xf
  v_mfma_f32_16x16x32_bf16 v[20:23], v[60:63], v[180:183], 0
  s_nop 0
  v_add_f32_dpp v237, v237, v237 row_ror:2 row_mask:0xf bank_mask:0xf
  v_mfma_f32_16x16x32_bf16 v[24:27], v[60:63], v[184:187], 0
  s_nop 0
  v_add_f32_dpp v237, v237, v237 row_ror:4 row_mask:0xf bank_mask:0xf
  v_mfma_f32_16x16x32_bf16 v[28:31], v[60:63], v[188:191], 0
  s_nop 0
  v_add_f32_dpp v237, v237, v237 row_ror:8 row_mask:0xf bank_mask:0xf
  v_mfma_f32_16x16x32_bf16 v[32:35], v[60:63], v[192:195], 0
  v_mov_b32 v54, v237
  s_nop 1
  v_permlane16_swap_b32 v237, v54
  v_add_f32 v237, v237, v54
  v_mfma_f32_16x16x32_bf16 v[36:39], v[60:63], v[196:199], 0
  v_mov_b32 v54, v237
  s_nop 1
  v_permlane32_swap_b32 v237, v54
  v_add_f32 v237, v237, v54
  v_mfma_f32_16x16x32_bf16 v[40:43], v[60:63], v[200:203], 0
  v_rcp_f32 v236, v237
  v_mfma_f32_16x16x32_bf16 v[44:47], v[60:63], v[204:207], 0
  v_cvt_pk_bf16_f32 v60, v16, v20
  v_cvt_pk_bf16_f32 v61, v24, v28
  v_cvt_pk_bf16_f32 v62, v32, v36
  s_nop 4
  v_cvt_pk_bf16_f32 v63, v40, v44
  ds_write_b128 v166, v[60:63] offset:20224
  v_readfirstlane_b32 s64, v238
  s_cmp_ge_u32 s3, 2
  s_waitcnt lgkmcnt(0)
  s_barrier
  s_nop 0
  s_cbranch_scc1 L_lx_sk
  ds_read_b64_tr_b16 v[48:49], v168 offset:20224
  ds_read_b64_tr_b16 v[50:51], v168 offset:21312
  s_waitcnt lgkmcnt(0)
  v_mfma_f32_16x16x32_bf16 v[52:55], v[48:51], v[96:99], 0
  s_cmp_eq_u32 s64, 0
  s_cbranch_scc1 L_lx_near
  s_nop 7
  v_mul_f32 v52, v52, v236
  v_mul_f32 v53, v53, v236
  v_mul_f32 v54, v54, v236
  v_mul_f32 v55, v55, v236
  v_cvt_pk_bf16_f32 v232, v52, v53
  v_cvt_pk_bf16_f32 v233, v54, v55
  buffer_store_dwordx4 v[232:235], v164, s[8:11], s52 offen sc1
  s_nop 0
  s_branch L_lx_done
L_lx_sk:
  s_waitcnt vmcnt(0) lgkmcnt(0)
  s_branch L_lx_done
L_lx_near:
  s_nop 5
  v_mul_f32 v52, v52, v236
  v_mul_f32 v53, v53, v236
  v_mul_f32 v54, v54, v236
  v_mul_f32 v55, v55, v236
  v_cvt_pk_bf16_f32 v232, v52, v53
  v_cvt_pk_bf16_f32 v233, v54, v55
  buffer_store_dwordx4 v[232:235], v164, s[8:11], s52 offen
  s_nop 1
L_lx_done:
  buffer_load_dwordx4 v[48:51], v169, s[8:11], s60 offen sc1
  s_waitcnt vmcnt(2)
  v_perm_b32 v80, v68, v64, s86
  v_perm_b32 v84, v68, v64, s87
  v_perm_b32 v81, v76, v72, s86
  v_perm_b32 v85, v76, v72, s87
  v_perm_b32 v88, v69, v65, s86
  v_perm_b32 v92, v69, v65, s87
  v_perm_b32 v89, v77, v73, s86
  v_perm_b32 v93, v77, v73, s87
  v_perm_b32 v82, v70, v66, s86
  v_perm_b32 v86, v70, v66, s87
  v_perm_b32 v83, v78, v74, s86
  v_perm_b32 v87, v78, v74, s87
  v_perm_b32 v90, v71, v67, s86
  v_perm_b32 v94, v71, v67, s87
  v_perm_b32 v91, v79, v75, s86
  v_perm_b32 v95, v79, v75, s87
  v_mov_b32_dpp v64, v80 row_ror:8 row_mask:0xf bank_mask:0xf
  v_mov_b32_dpp v65, v81 row_ror:8 row_mask:0xf bank_mask:0xf
  v_mov_b32_dpp v66, v84 row_ror:8 row_mask:0xf bank_mask:0xf
  v_mov_b32_dpp v67, v85 row_ror:8 row_mask:0xf bank_mask:0xf
  v_mov_b32_dpp v68, v88 row_ror:8 row_mask:0xf bank_mask:0xf
  v_mov_b32_dpp v69, v89 row_ror:8 row_mask:0xf bank_mask:0xf
  v_mov_b32_dpp v70, v92 row_ror:8 row_mask:0xf bank_mask:0xf
  v_mov_b32_dpp v71, v93 row_ror:8 row_mask:0xf bank_mask:0xf
  v_mov_b32_dpp v80, v82 row_ror:8 row_mask:0xf bank_mask:0xc
  v_mov_b32_dpp v81, v83 row_ror:8 row_mask:0xf bank_mask:0xc
  v_mov_b32_dpp v84, v86 row_ror:8 row_mask:0xf bank_mask:0xc
  v_mov_b32_dpp v85, v87 row_ror:8 row_mask:0xf bank_mask:0xc
  v_mov_b32_dpp v88, v90 row_ror:8 row_mask:0xf bank_mask:0xc
  v_mov_b32_dpp v89, v91 row_ror:8 row_mask:0xf bank_mask:0xc
  v_mov_b32_dpp v92, v94 row_ror:8 row_mask:0xf bank_mask:0xc
  v_mov_b32_dpp v93, v95 row_ror:8 row_mask:0xf bank_mask:0xc
  v_mov_b32_dpp v82, v64 quad_perm:[0,1,2,3] row_mask:0xf bank_mask:0x3
  v_mov_b32_dpp v83, v65 quad_perm:[0,1,2,3] row_mask:0xf bank_mask:0x3
  v_mov_b32_dpp v86, v66 quad_perm:[0,1,2,3] row_mask:0xf bank_mask:0x3
  v_mov_b32_dpp v87, v67 quad_perm:[0,1,2,3] row_mask:0xf bank_mask:0x3
  v_mov_b32_dpp v90, v68 quad_perm:[0,1,2,3] row_mask:0xf bank_mask:0x3
  v_mov_b32_dpp v91, v69 quad_perm:[0,1,2,3] row_mask:0xf bank_mask:0x3
  v_mov_b32_dpp v94, v70 quad_perm:[0,1,2,3] row_mask:0xf bank_mask:0x3
  v_mov_b32_dpp v95, v71 quad_perm:[0,1,2,3] row_mask:0xf bank_mask:0x3
  s_nop 0
  s_branch L_lx_31_w
L_lx_31:
  buffer_load_dwordx4 v[48:51], v169, s[8:11], s60 offen sc1
L_lx_31_w:
  s_waitcnt vmcnt(0)
  v_cmp_ne_u64 vcc, s[88:89], v[50:51]
  s_mov_b64 exec, vcc
  s_cbranch_vccz L_lxd_32
  s_sub_u32 s7, s7, 1
  s_cbranch_scc0 L_lx_31
  s_branch L_exit
L_lxd_32:
  s_mov_b64 exec, -1
  v_mov_b32_dpp v50, v48 row_ror:8 row_mask:0xf bank_mask:0xf
  v_mov_b32_dpp v51, v49 row_ror:8 row_mask:0xf bank_mask:0xf
  s_nop 1
  v_mfma_f32_16x16x32_bf16 v[16:19], v[48:51], v[80:83], 0
  v_mfma_f32_16x16x32_bf16 v[20:23], v[48:51], v[84:87], 0
  v_mfma_f32_16x16x32_bf16 v[24:27], v[48:51], v[88:91], 0
  v_mfma_f32_16x16x32_bf16 v[28:31], v[48:51], v[92:95], 0
  s_nop 4
  v_add_f32 v16, v16, v17
  v_add_f32 v18, v18, v19
  v_add_f32 v20, v20, v21
  v_add_f32 v22, v22, v23
  v_permlane16_swap_b32 v16, v18
  v_add_f32 v24, v24, v25
  v_add_f32 v26, v26, v27
  v_permlane16_swap_b32 v20, v22
  v_add_f32 v28, v28, v29
  v_add_f32 v30, v30, v31
  v_permlane16_swap_b32 v24, v26
  v_add_f32_dpp v52, v18, v16 row_shl:4 row_mask:0xf bank_mask:0xf bound_ctrl:0
  v_add_f32_dpp v53, v22, v20 row_shl:4 row_mask:0xf bank_mask:0xf bound_ctrl:0
  v_permlane16_swap_b32 v28, v30
  v_add_f32_dpp v54, v26, v24 row_shl:4 row_mask:0xf bank_mask:0xf bound_ctrl:0
  s_nop 0
  v_add_f32_dpp v55, v30, v28 row_shl:4 row_mask:0xf bank_mask:0xf bound_ctrl:0
  ds_write_b128 v170, v[52:55]
  ds_add_rtn_u32 v4, v15, v3 offset:26184
  ds_read2st64_b32 v[16:17], v171 offset0:0 offset1:1
  ds_read2st64_b32 v[18:19], v171 offset0:2 offset1:3
  ds_read2st64_b32 v[20:21], v171 offset0:4 offset1:5
  ds_read2st64_b32 v[22:23], v171 offset0:6 offset1:7
  s_waitcnt lgkmcnt(2)
  v_readfirstlane_b32 s68, v4
  v_pk_add_f32 v[16:17], v[16:17], v[18:19]
  s_cmp_lg_u32 s68, 7
  s_cbranch_scc1 L_la_o
  s_waitcnt lgkmcnt(0)
  v_pk_add_f32 v[20:21], v[20:21], v[22:23]
  v_pk_add_f32 v[16:17], v[16:17], v[20:21]
  v_add_f32 v16, v16, v17
  s_nop 1
  v_mov_b32_dpp v17, v16 quad_perm:[1,1,3,3] row_mask:0xf bank_mask:0xf
  v_cvt_pk_bf16_f32 v232, v16, v17
  s_nop 1
  v_mov_b32_dpp v233, v232 quad_perm:[2,2,2,2] row_mask:0xf bank_mask:0xf
  buffer_store_dwordx4 v[232:235], v174, s[8:11], s61 offen sc1
  ds_add_u32 v15, v3 offset:26184
  s_nop 0
L_la_o:
  s_cmp_lt_u32 s3, 4
  s_cbranch_scc1 L_done
  s_cmp_lt_u32 s91, 14
  s_cbranch_scc1 L_done
L_wc_33:
  ds_read_b32 v4, v2 offset:26184
  s_waitcnt lgkmcnt(0)
  v_readfirstlane_b32 s68, v4
  s_cmp_ge_u32 s68, 9
  s_nop 2
  s_cbranch_scc1 L_wcd_34
  s_sleep 2
  s_sub_u32 s7, s7, 1
  s_cbranch_scc0 L_wc_33
  s_branch L_exit
L_wcd_34:
  s_branch L_RS
L_RS:
  s_mov_b32 s12, s40
  s_mov_b32 s13, s41
  s_mov_b32 s14, 2048
  s_mov_b32 s15, 0x00020000
  s_mov_b32 s48, s16
  s_mov_b32 s49, s17
  s_mov_b32 s50, 2048
  s_mov_b32 s51, 0x00020000
  s_lshl_b32 s54, s93, 11
  s_add_u32 s54, s54, 99328
  s_lshl_b32 s64, s93, 4
  v_mov_b32 v239, s64
  v_mov_b32 v234, s88
  v_mov_b32 v235, s89
  s_lshl_b32 s63, s4, 1
  s_add_u32 s63, s63, s91
  s_sub_u32 s63, s63, 14
  v_and_b32 v18, 31, v1
  s_lshl_b32 s64, s63, 5
  v_add_u32 v18, s64, v18
  v_lshlrev_b32 v248, 1, v18
  v_lshrrev_b32 v249, 2, v18
  v_lshlrev_b32 v249, 4, v249
  s_lshl_b32 s100, s93, 13
  s_add_u32 s100, s100, 1179648
  s_add_u32 s101, s100, 6144
  s_lshl_b32 s62, s93, 10
  s_cmp_lg_u32 s6, 0
  s_cbranch_scc1 L_prep_done
  buffer_load_ushort v250, v248, s[48:51], s62 offen
  s_mov_b64 s[70:71], -1
  s_mov_b64 s[72:73], -1
  s_mov_b64 s[74:75], -1
  s_mov_b64 s[76:77], -1
  s_mov_b64 s[78:79], -1
  s_mov_b64 s[80:81], -1
  s_mov_b64 s[82:83], -1
  s_mov_b64 s[84:85], -1
  s_branch L_gse_42
L_gpo_43:
L_gp_39:
  s_mov_b64 exec, s[70:71]
  s_cbranch_execz L_gs_44
  s_add_u32 s66, s100, 0
  buffer_load_dwordx4 v[64:67], v249, s[8:11], s66 offen sc1
L_gs_44:
  s_mov_b64 exec, s[72:73]
  s_cbranch_execz L_gs_45
  s_add_u32 s66, s100, 16384
  buffer_load_dwordx4 v[68:71], v249, s[8:11], s66 offen sc1
L_gs_45:
  s_mov_b64 exec, s[74:75]
  s_cbranch_execz L_gs_46
  s_add_u32 s66, s100, 32768
  buffer_load_dwordx4 v[72:75], v249, s[8:11], s66 offen sc1
L_gs_46:
  s_mov_b64 exec, s[76:77]
  s_cbranch_execz L_gs_47
  s_add_u32 s66, s100, 49152
  buffer_load_dwordx4 v[76:79], v249, s[8:11], s66 offen sc1
L_gs_47:
  s_mov_b64 exec, s[78:79]
  s_cbranch_execz L_gs_48
  s_add_u32 s66, s101, 0
  buffer_load_dwordx4 v[80:83], v249, s[8:11], s66 offen sc1
L_gs_48:
  s_mov_b64 exec, s[80:81]
  s_cbranch_execz L_gs_49
  s_add_u32 s66, s101, 16384
  buffer_load_dwordx4 v[84:87], v249, s[8:11], s66 offen sc1
L_gs_49:
  s_mov_b64 exec, s[82:83]
  s_cbranch_execz L_gs_50
  s_add_u32 s66, s101, 32768
  buffer_load_dwordx4 v[88:91], v249, s[8:11], s66 offen sc1
L_gs_50:
  s_mov_b64 exec, s[84:85]
  s_cbranch_execz L_gs_51
  s_add_u32 s66, s101, 49152
  buffer_load_dwordx4 v[92:95], v249, s[8:11], s66 offen sc1
L_gs_51:
L_gw_41:
  s_waitcnt vmcnt(0)
  s_mov_b64 exec, s[70:71]
  v_cmp_ne_u64_e64 s[70:71], s[88:89], v[66:67]
  s_mov_b64 exec, s[72:73]
  v_cmp_ne_u64_e64 s[72:73], s[88:89], v[70:71]
  s_mov_b64 exec, s[74:75]
  v_cmp_ne_u64_e64 s[74:75], s[88:89], v[74:75]
  s_mov_b64 exec, s[76:77]
  v_cmp_ne_u64_e64 s[76:77], s[88:89], v[78:79]
  s_mov_b64 exec, s[78:79]
  v_cmp_ne_u64_e64 s[78:79], s[88:89], v[82:83]
  s_mov_b64 exec, s[80:81]
  v_cmp_ne_u64_e64 s[80:81], s[88:89], v[86:87]
  s_mov_b64 exec, s[82:83]
  v_cmp_ne_u64_e64 s[82:83], s[88:89], v[90:91]
  s_mov_b64 exec, s[84:85]
  v_cmp_ne_u64_e64 s[84:85], s[88:89], v[94:95]
  s_mov_b64 exec, -1
  s_mov_b64 s[68:69], s[70:71]
  s_or_b64 s[68:69], s[68:69], s[72:73]
  s_or_b64 s[68:69], s[68:69], s[74:75]
  s_or_b64 s[68:69], s[68:69], s[76:77]
  s_or_b64 s[68:69], s[68:69], s[78:79]
  s_or_b64 s[68:69], s[68:69], s[80:81]
  s_or_b64 s[68:69], s[68:69], s[82:83]
  s_or_b64 s[68:69], s[68:69], s[84:85]
  s_cmp_eq_u64 s[68:69], 0
  s_cbranch_scc1 L_gpd_40
  s_sub_u32 s7, s7, 1
  s_cbranch_scc1 L_exit
  s_bcnt1_i32_b64 s67, s[68:69]
  s_cmp_le_u32 s67, 0
  s_cbranch_scc1 L_gp_39
L_gse_42:
  s_cmp_eq_u64 s[70:71], 0
  s_cbranch_scc1 L_gn_52
  s_and_b64 s[68:69], s[70:71], s[96:97]
  s_cselect_b64 s[68:69], s[68:69], s[70:71]
  s_ff1_i32_b64 s68, s[68:69]
  s_lshl_b64 exec, 1, s68
L_gsp_53:
  s_add_u32 s66, s100, 0
  buffer_load_dwordx4 v[64:67], v249, s[8:11], s66 offen sc1
  s_waitcnt vmcnt(0)
  v_cmp_eq_u64 vcc, s[88:89], v[66:67]
  s_nop 0
  s_cbranch_vccnz L_gpo_43
  s_sleep 1
  s_sub_u32 s7, s7, 1
  s_cbranch_scc0 L_gsp_53
  s_branch L_exit
L_gn_52:
  s_cmp_eq_u64 s[72:73], 0
  s_cbranch_scc1 L_gn_54
  s_and_b64 s[68:69], s[72:73], s[96:97]
  s_cselect_b64 s[68:69], s[68:69], s[72:73]
  s_ff1_i32_b64 s68, s[68:69]
  s_lshl_b64 exec, 1, s68
L_gsp_55:
  s_add_u32 s66, s100, 16384
  buffer_load_dwordx4 v[68:71], v249, s[8:11], s66 offen sc1
  s_waitcnt vmcnt(0)
  v_cmp_eq_u64 vcc, s[88:89], v[70:71]
  s_nop 0
  s_cbranch_vccnz L_gpo_43
  s_sleep 1
  s_sub_u32 s7, s7, 1
  s_cbranch_scc0 L_gsp_55
  s_branch L_exit
L_gn_54:
  s_cmp_eq_u64 s[74:75], 0
  s_cbranch_scc1 L_gn_56
  s_and_b64 s[68:69], s[74:75], s[96:97]
  s_cselect_b64 s[68:69], s[68:69], s[74:75]
  s_ff1_i32_b64 s68, s[68:69]
  s_lshl_b64 exec, 1, s68
L_gsp_57:
  s_add_u32 s66, s100, 32768
  buffer_load_dwordx4 v[72:75], v249, s[8:11], s66 offen sc1
  s_waitcnt vmcnt(0)
  v_cmp_eq_u64 vcc, s[88:89], v[74:75]
  s_nop 0
  s_cbranch_vccnz L_gpo_43
  s_sleep 1
  s_sub_u32 s7, s7, 1
  s_cbranch_scc0 L_gsp_57
  s_branch L_exit
L_gn_56:
  s_cmp_eq_u64 s[76:77], 0
  s_cbranch_scc1 L_gn_58
  s_and_b64 s[68:69], s[76:77], s[96:97]
  s_cselect_b64 s[68:69], s[68:69], s[76:77]
  s_ff1_i32_b64 s68, s[68:69]
  s_lshl_b64 exec, 1, s68
L_gsp_59:
  s_add_u32 s66, s100, 49152
  buffer_load_dwordx4 v[76:79], v249, s[8:11], s66 offen sc1
  s_waitcnt vmcnt(0)
  v_cmp_eq_u64 vcc, s[88:89], v[78:79]
  s_nop 0
  s_cbranch_vccnz L_gpo_43
  s_sleep 1
  s_sub_u32 s7, s7, 1
  s_cbranch_scc0 L_gsp_59
  s_branch L_exit
L_gn_58:
  s_cmp_eq_u64 s[78:79], 0
  s_cbranch_scc1 L_gn_60
  s_and_b64 s[68:69], s[78:79], s[96:97]
  s_cselect_b64 s[68:69], s[68:69], s[78:79]
  s_ff1_i32_b64 s68, s[68:69]
  s_lshl_b64 exec, 1, s68
L_gsp_61:
  s_add_u32 s66, s101, 0
  buffer_load_dwordx4 v[80:83], v249, s[8:11], s66 offen sc1
  s_waitcnt vmcnt(0)
  v_cmp_eq_u64 vcc, s[88:89], v[82:83]
  s_nop 0
  s_cbranch_vccnz L_gpo_43
  s_sleep 1
  s_sub_u32 s7, s7, 1
  s_cbranch_scc0 L_gsp_61
  s_branch L_exit
L_gn_60:
  s_cmp_eq_u64 s[80:81], 0
  s_cbranch_scc1 L_gn_62
  s_and_b64 s[68:69], s[80:81], s[96:97]
  s_cselect_b64 s[68:69], s[68:69], s[80:81]
  s_ff1_i32_b64 s68, s[68:69]
  s_lshl_b64 exec, 1, s68
L_gsp_63:
  s_add_u32 s66, s101, 16384
  buffer_load_dwordx4 v[84:87], v249, s[8:11], s66 offen sc1
  s_waitcnt vmcnt(0)
  v_cmp_eq_u64 vcc, s[88:89], v[86:87]
  s_nop 0
  s_cbranch_vccnz L_gpo_43
  s_sleep 1
  s_sub_u32 s7, s7, 1
  s_cbranch_scc0 L_gsp_63
  s_branch L_exit
L_gn_62:
  s_cmp_eq_u64 s[82:83], 0
  s_cbranch_scc1 L_gn_64
  s_and_b64 s[68:69], s[82:83], s[96:97]
  s_cselect_b64 s[68:69], s[68:69], s[82:83]
  s_ff1_i32_b64 s68, s[68:69]
  s_lshl_b64 exec, 1, s68
L_gsp_65:
  s_add_u32 s66, s101, 32768
  buffer_load_dwordx4 v[88:91], v249, s[8:11], s66 offen sc1
  s_waitcnt vmcnt(0)
  v_cmp_eq_u64 vcc, s[88:89], v[90:91]
  s_nop 0
  s_cbranch_vccnz L_gpo_43
  s_sleep 1
  s_sub_u32 s7, s7, 1
  s_cbranch_scc0 L_gsp_65
  s_branch L_exit
L_gn_64:
  s_cmp_eq_u64 s[84:85], 0
  s_cbranch_scc1 L_gn_66
  s_and_b64 s[68:69], s[84:85], s[96:97]
  s_cselect_b64 s[68:69], s[68:69], s[84:85]
  s_ff1_i32_b64 s68, s[68:69]
  s_lshl_b64 exec, 1, s68
L_gsp_67:
  s_add_u32 s66, s101, 49152
  buffer_load_dwordx4 v[92:95], v249, s[8:11], s66 offen sc1
  s_waitcnt vmcnt(0)
  v_cmp_eq_u64 vcc, s[88:89], v[94:95]
  s_nop 0
  s_cbranch_vccnz L_gpo_43
  s_sleep 1
  s_sub_u32 s7, s7, 1
  s_cbranch_scc0 L_gsp_67
  s_branch L_exit
L_gn_66:
L_gpd_40:
  v_and_b32 v17, 3, v1
  v_cmp_gt_u32 vcc, 2, v17
  v_and_b32 v22, 1, v17
  v_lshlrev_b32 v22, 4, v22
  v_mov_b32 v251, 0
  v_mov_b32 v252, 0
  v_cndmask_b32 v64, v65, v64, vcc
  v_lshrrev_b32 v64, v22, v64
  v_lshlrev_b32 v64, 16, v64
  v_add_f32 v251, v251, v64
  v_cndmask_b32 v68, v69, v68, vcc
  v_lshrrev_b32 v68, v22, v68
  v_lshlrev_b32 v68, 16, v68
  v_add_f32 v251, v251, v68
  v_cndmask_b32 v72, v73, v72, vcc
  v_lshrrev_b32 v72, v22, v72
  v_lshlrev_b32 v72, 16, v72
  v_add_f32 v251, v251, v72
  v_cndmask_b32 v76, v77, v76, vcc
  v_lshrrev_b32 v76, v22, v76
  v_lshlrev_b32 v76, 16, v76
  v_add_f32 v251, v251, v76
  v_cndmask_b32 v80, v81, v80, vcc
  v_lshrrev_b32 v80, v22, v80
  v_lshlrev_b32 v80, 16, v80
  v_add_f32 v252, v252, v80
  v_cndmask_b32 v84, v85, v84, vcc
  v_lshrrev_b32 v84, v22, v84
  v_lshlrev_b32 v84, 16, v84
  v_add_f32 v252, v252, v84
  v_cndmask_b32 v88, v89, v88, vcc
  v_lshrrev_b32 v88, v22, v88
  v_lshlrev_b32 v88, 16, v88
  v_add_f32 v252, v252, v88
  v_cndmask_b32 v92, v93, v92, vcc
  v_lshrrev_b32 v92, v22, v92
  v_lshlrev_b32 v92, 16, v92
  v_add_f32 v252, v252, v92
  v_lshlrev_b32 v250, 16, v250
  s_nop 1
L_prep_done:
  v_lshrrev_b32 v11, 3, v1
  v_and_b32 v16, 7, v1
  v_lshlrev_b32 v16, 4, v16
  v_lshl_add_u32 v9, v11, 12, v16
  v_lshl_add_u32 v11, v11, 11, v16
  s_lshl_b32 s64, s6, 7
  s_add_u32 s64, s64, s54
  v_lshlrev_b32 v12, 5, v6
  v_lshl_add_u32 v12, v7, 4, v12
  v_add_u32 v12, s64, v12
  v_bfe_u32 v16, v1, 2, 3
  v_and_b32 v17, 3, v1
  v_lshlrev_b32 v14, 5, v17
  v_lshl_add_u32 v14, v16, 2, v14
  v_add_u32 v14, s54, v14
  v_add_u32 v60, 20224, v14
  s_lshl_b32 s64, s6, 8
  s_add_u32 s64, s64, s54
  v_lshlrev_b32 v13, 5, v6
  v_and_b32 v16, 1, v7
  v_lshl_add_u32 v13, v16, 4, v13
  v_lshrrev_b32 v16, 1, v7
  v_lshl_add_u32 v13, v16, 7, v13
  v_add_u32 v13, s64, v13
  v_bfe_u32 v5, v1, 1, 4
  v_lshlrev_b32 v5, 4, v5
  v_and_b32 v16, 1, v1
  v_lshl_add_u32 v5, v16, 13, v5
  v_lshrrev_b32 v16, 5, v1
  v_lshl_add_u32 v5, v16, 14, v5
  s_lshl_b32 s61, s93, 11
  s_lshl_b32 s66, s63, 7
  s_add_u32 s61, s61, s66
  s_add_u32 s61, s61, 262144
  v_mov_b32 v16, 0x3f80
  v_mov_b32 v19, 0x3f800000
  v_mov_b32 v58, 0
  v_mov_b32 v59, 0
  v_cmp_eq_u32 vcc, 0, v6
  s_nop 1
  v_cndmask_b32 v56, 0, v16, vcc
  v_cmp_eq_u32 vcc, 1, v6
  s_nop 1
  v_cndmask_b32 v56, v56, v19, vcc
  v_cmp_eq_u32 vcc, 2, v6
  s_nop 1
  v_cndmask_b32 v57, 0, v16, vcc
  v_cmp_eq_u32 vcc, 3, v6
  s_nop 1
  v_cndmask_b32 v57, v57, v19, vcc
  v_mov_b32 v18, 0
  v_mov_b32 v19, 0
  v_mov_b32 v22, 0
  v_mov_b32 v23, 0
  v_mov_b32 v26, 0
  v_mov_b32 v27, 0
  v_mov_b32 v30, 0
  v_mov_b32 v31, 0
  v_and_b32 v42, 31, v1
  v_lshl_add_u32 v42, v42, 3, s54
  v_mov_b32 v44, 0x7ff00000
  v_cmp_eq_u32 vcc, 0, v1
  s_nop 1
  v_cndmask_b32 v43, v44, v239, vcc
  v_cmp_gt_u32 vcc, 32, v1
  s_nop 1
  v_cndmask_b32 v248, v44, v248, vcc
  v_cmp_gt_u32 vcc, 4, v6
  s_nop 1
  v_cndmask_b32 v13, v44, v13, vcc
  s_cmp_lg_u32 s6, 0
  s_cbranch_scc1 L_rs2
  buffer_load_dwordx4 v[96:99], v9, s[8:11], s61 offen sc1
L_pp_68:
  s_waitcnt vmcnt(0)
  v_cmp_ne_u64_e64 vcc, s[88:89], v[98:99]
  s_nop 0
  s_cbranch_vccz L_ppd_70
  s_sleep 2
  buffer_load_dwordx4 v[96:99], v9, s[8:11], s61 offen sc1
  s_sub_u32 s7, s7, 1
  s_cbranch_scc0 L_pp_68
  s_branch L_exit
L_ppd_70:
  v_mov_b32 v16, v96
  v_mov_b32 v17, v97
  s_nop 1
L_ppe_69:
  v_mfma_f32_16x16x32_bf16 v[32:35], v[16:19], v[56:59], 0
  s_nop 7
  v_mov_b32 v36, v32
  v_mov_b32 v37, v33
  v_mov_b32 v38, v34
  v_mov_b32 v39, v35
  v_permlane32_swap_b32 v32, v36
  v_permlane32_swap_b32 v33, v37
  v_permlane32_swap_b32 v34, v38
  v_permlane32_swap_b32 v35, v39
  v_pk_add_f32 v[32:33], v[32:33], v[36:37]
  v_pk_add_f32 v[34:35], v[34:35], v[38:39]
  s_mov_b64 exec, 0x000f000f
  ds_write_b128 v12, v[32:35] offset:19712
  s_mov_b64 exec, -1
  s_mov_b64 exec, 1
  ds_add_u32 v239, v3 offset:26244
  s_mov_b64 exec, -1
  ds_read_b32 v40, v14 offset:19712
  s_waitcnt lgkmcnt(0)
  v_fma_f32 v238, v251, v40, v250
  v_mov_b32 v40, v238
  v_mov_b32 v41, v252
  ds_write_b64 v42, v[40:41] offset:19968
  ds_add_u32 v43, v3 offset:26244
  s_add_u32 s64, s63, s93
  s_cmp_lg_u32 s64, 0
  s_cbranch_scc1 L_rs2
  s_mov_b64 exec, 1
  buffer_store_dword v2, v2, s[56:59], 0 offen offset:128 sc1
  s_mov_b64 exec, -1
L_rs2:
  s_lshl_b32 s61, s93, 11
  s_bitset0_b32 s61, 31
  s_lshl_b32 s64, s6, 17
  s_add_u32 s61, s61, s64
  s_lshl_b32 s64, s63, 7
  s_add_u32 s61, s61, s64
  s_add_u32 s61, s61, 720896
  s_cmp_eq_u32 s6, 3
  s_cselect_b64 s[94:95], 0, -1
  s_cselect_b32 s64, 0, 65536
  s_add_u32 s60, s61, 32768
  s_add_u32 s100, s61, s64
  s_add_u32 s101, s60, s64
L_wc_71:
  ds_read_b32 v4, v239 offset:26244
  ds_read_b64 v[40:41], v42 offset:19968
  s_waitcnt lgkmcnt(0)
  v_readfirstlane_b32 s68, v4
  s_cmp_ge_u32 s68, 2
  s_nop 2
  s_cbranch_scc1 L_wcd_72
  s_sleep 2
  s_sub_u32 s7, s7, 1
  s_cbranch_scc0 L_wc_71
  s_branch L_exit
L_wcd_72:
  s_lshl_b32 s65, s4, 7
  s_add_u32 s65, s65, 63488
  v_lshlrev_b32 v46, 2, v1
  s_mov_b32 s69, 0
  s_nop 0
L_rn_73:
  s_mov_b64 exec, 0x3fff
  buffer_load_dword v47, v46, s[8:11], s65 offen sc1
  s_waitcnt vmcnt(0)
  v_cmp_ne_u32 vcc, s88, v47
  s_bcnt1_i32_b64 s67, vcc
  s_cmp_le_u32 s67, 4
  s_cbranch_scc1 L_rnd_74
  s_add_u32 s69, s69, 1
  s_and_b32 s67, s69, 31
  s_cbranch_scc1 L_rn_73
  s_mov_b64 exec, 1
  buffer_load_dwordx4 v[128:131], v9, s[8:11], s61 offen sc1
  s_waitcnt vmcnt(0)
  v_cmp_ne_u64 vcc, s[88:89], v[130:131]
  s_nop 0
  s_cbranch_vccz L_rnd_74
  s_sub_u32 s7, s7, 1
  s_cbranch_scc0 L_rn_73
  s_branch L_exit
L_rnd_74:
  s_mov_b64 exec, -1
  v_cndmask_b32 v58, 0, v56, s[94:95]
  v_cndmask_b32 v59, 0, v57, s[94:95]
  s_mov_b64 s[70:71], -1
  s_mov_b64 s[72:73], -1
  s_mov_b64 s[74:75], -1
  s_mov_b64 s[76:77], -1
L_r2_75:
  s_mov_b64 exec, s[70:71]
  buffer_load_dwordx4 v[128:131], v9, s[8:11], s61 offen sc1
  s_mov_b64 exec, s[72:73]
  buffer_load_dwordx4 v[132:135], v9, s[8:11], s60 offen sc1
  s_mov_b64 exec, s[74:75]
  buffer_load_dwordx4 v[136:139], v9, s[8:11], s100 offen sc1
  s_mov_b64 exec, s[76:77]
  buffer_load_dwordx4 v[140:143], v9, s[8:11], s101 offen sc1
  s_mov_b64 exec, -1
  s_waitcnt vmcnt(3)
  v_mfma_f32_16x16x16_bf16 v[32:35], v[128:129], v[56:57], 0
  v_cmp_ne_u64_e64 s[70:71], s[88:89], v[130:131]
  s_waitcnt vmcnt(2)
  v_mfma_f32_16x16x16_bf16 v[32:35], v[132:133], v[56:57], v[32:35]
  v_cmp_ne_u64_e64 s[72:73], s[88:89], v[134:135]
  s_or_b64 s[68:69], s[70:71], s[72:73]
  s_waitcnt vmcnt(1)
  v_mfma_f32_16x16x16_bf16 v[32:35], v[136:137], v[58:59], v[32:35]
  v_cmp_ne_u64_e64 s[74:75], s[88:89], v[138:139]
  s_or_b64 s[68:69], s[68:69], s[74:75]
  s_waitcnt vmcnt(0)
  v_mfma_f32_16x16x16_bf16 v[32:35], v[140:141], v[58:59], v[32:35]
  v_cmp_ne_u64_e64 s[76:77], s[88:89], v[142:143]
  s_or_b64 s[68:69], s[68:69], s[76:77]
  s_nop 4
  s_cbranch_scc0 L_r2d_76
  s_sub_u32 s7, s7, 1
  s_cbranch_scc0 L_r2_75
  s_branch L_exit
L_r2d_76:
  ds_write_b128 v13, v[32:35] offset:20224
  ds_add_rtn_u32 v4, v43, v3 offset:26248
  ds_read2_b32 v[16:17], v60 offset0:0 offset1:32
  ds_read2_b32 v[18:19], v60 offset0:64 offset1:96
  ds_read2_b32 v[20:21], v60 offset0:128 offset1:160
  ds_read2_b32 v[22:23], v60 offset0:192 offset1:224
  s_waitcnt lgkmcnt(2)
  v_readfirstlane_b32 s68, v4
  v_pk_add_f32 v[16:17], v[16:17], v[18:19]
  s_cmp_lg_u32 s68, 3
  s_cbranch_scc1 L_done
  s_waitcnt lgkmcnt(0)
  v_pk_add_f32 v[20:21], v[20:21], v[22:23]
  v_pk_add_f32 v[16:17], v[16:17], v[20:21]
  v_add_f32 v16, v16, v17
  v_fma_f32 v16, v41, v16, v40
  v_cvt_pk_bf16_f32 v16, v16, v16
  buffer_store_short v16, v248, s[12:15], s62 offen
  s_branch L_done
L_N:
  s_mov_b32 s50, 4194304
  s_mov_b32 s51, 0x00020000
  s_cmp_ge_u32 s3, 4
  s_cbranch_scc1 L_N_pfb
  v_lshrrev_b32 v9, 3, v1
  v_lshlrev_b32 v9, 13, v9
  v_and_b32 v11, 7, v1
  v_lshl_add_u32 v9, v11, 7, v9
  s_lshr_b32 s64, s91, 3
  s_lshl_b32 s65, s4, 1
  s_add_u32 s64, s64, s65
  s_lshl_b32 s64, s64, 2
  s_add_u32 s64, s64, s6
  s_lshl_b32 s64, s64, 16
  s_and_b32 s65, s91, 7
  s_lshl_b32 s65, s65, 10
  s_add_u32 s64, s64, s65
  s_waitcnt lgkmcnt(0)
  s_mov_b32 s48, s20
  s_mov_b32 s49, s21
  buffer_load_dword v65, v9, s[48:51], s64 offen
  s_branch L_N_pfd
L_N_pfb:
  v_lshrrev_b32 v9, 1, v1
  v_lshlrev_b32 v9, 13, v9
  v_and_b32 v11, 1, v1
  v_lshl_add_u32 v9, v11, 7, v9
  s_lshl_b32 s64, s90, 2
  s_add_u32 s64, s64, s6
  s_lshl_b32 s64, s64, 18
  s_lshl_b32 s65, s46, 8
  s_add_u32 s64, s64, s65
  s_waitcnt lgkmcnt(0)
  s_mov_b32 s48, s22
  s_mov_b32 s49, s23
  buffer_load_dword v65, v9, s[48:51], s64 offen
L_N_pfd:
  s_mov_b32 s12, s18
  s_mov_b32 s13, s19
  s_mov_b32 s14, 16777216
  s_mov_b32 s15, 0x00020000
  s_mov_b32 s8, s44
  s_mov_b32 s9, s45
  s_mov_b32 s10, 16777216
  s_mov_b32 s11, 0x00020000
  s_mov_b32 s56, s42
  s_mov_b32 s57, s43
  s_mov_b32 s58, 256
  s_mov_b32 s59, 0x00020000
  s_cmp_lg_u32 s2, 64
  s_cbranch_scc1 L_noep
  s_cmp_lg_u32 s3, 0
  s_cbranch_scc1 L_noep
  s_or_b32 s67, s94, 1
  v_mov_b32 v62, s67
  s_mov_b64 exec, 1
  buffer_store_dword v62, v2, s[56:59], 0 offen offset:128 sc1
  s_mov_b64 exec, -1
L_noep:
  s_cmp_lg_u32 s3, 1
  s_cbranch_scc1 L_N_noqp2
  s_lshl_b32 s64, s46, 11
  s_lshl_b32 s65, s90, 9
  s_add_u32 s64, s64, s65
  s_add_u32 s64, s64, 1835008
  v_lshlrev_b32 v9, 7, v1
  s_mov_b64 exec, 15
  buffer_load_dword v67, v9, s[8:11], s64 offen sc1
  s_mov_b64 exec, -1
L_N_noqp2:
  s_barrier
  s_lshl_b32 s64, s47, 17
  s_lshl_b32 s65, s3, 14
  s_add_u32 s64, s64, s65
  s_lshl_b32 s66, s6, 1
  s_lshr_b32 s65, s3, 2
  s_add_u32 s66, s66, s65
  s_mul_i32 s65, s66, 16896
  s_add_u32 m0, s65, 26368
  s_nop 0
  buffer_load_dwordx4 v8, s[12:15], s64 offen nt lds
  s_addk_i32 m0, 1056
  s_add_u32 s64, s64, 1024
  buffer_load_dwordx4 v8, s[12:15], s64 offen nt lds
  s_addk_i32 m0, 1056
  s_add_u32 s64, s64, 1024
  buffer_load_dwordx4 v8, s[12:15], s64 offen nt lds
  s_addk_i32 m0, 1056
  s_add_u32 s64, s64, 1024
  buffer_load_dwordx4 v8, s[12:15], s64 offen nt lds
  s_addk_i32 m0, 1056
  s_add_u32 s64, s64, 1024
  buffer_load_dwordx4 v8, s[12:15], s64 offen nt lds
  s_addk_i32 m0, 1056
  s_add_u32 s64, s64, 1024
  buffer_load_dwordx4 v8, s[12:15], s64 offen nt lds
  s_addk_i32 m0, 1056
  s_add_u32 s64, s64, 1024
  buffer_load_dwordx4 v8, s[12:15], s64 offen nt lds
  s_addk_i32 m0, 1056
  s_add_u32 s64, s64, 1024
  buffer_load_dwordx4 v8, s[12:15], s64 offen nt lds
  s_addk_i32 m0, 1056
  s_add_u32 s64, s64, 1024
  buffer_load_dwordx4 v8, s[12:15], s64 offen nt lds
  s_addk_i32 m0, 1056
  s_add_u32 s64, s64, 1024
  buffer_load_dwordx4 v8, s[12:15], s64 offen nt lds
  s_addk_i32 m0, 1056
  s_add_u32 s64, s64, 1024
  buffer_load_dwordx4 v8, s[12:15], s64 offen nt lds
  s_addk_i32 m0, 1056
  s_add_u32 s64, s64, 1024
  buffer_load_dwordx4 v8, s[12:15], s64 offen nt lds
  s_addk_i32 m0, 1056
  s_add_u32 s64, s64, 1024
  buffer_load_dwordx4 v8, s[12:15], s64 offen nt lds
  s_addk_i32 m0, 1056
  s_add_u32 s64, s64, 1024
  buffer_load_dwordx4 v8, s[12:15], s64 offen nt lds
  s_addk_i32 m0, 1056
  s_add_u32 s64, s64, 1024
  buffer_load_dwordx4 v8, s[12:15], s64 offen nt lds
  s_addk_i32 m0, 1056
  s_add_u32 s64, s64, 1024
  buffer_load_dwordx4 v8, s[12:15], s64 offen nt lds
  v_lshlrev_b32 v14, 4, v6
  s_mul_i32 s95, s4, 14
  s_add_u32 s95, s95, s91
  s_lshl_b32 s64, s6, 2
  v_mov_b32 v13, s64
  s_cmp_ge_u32 s3, 4
  s_cbranch_scc1 L_NB
  s_lshr_b32 s64, s47, 6
  s_lshl_b32 s62, s64, 15
  s_lshl_b32 s65, s6, 10
  s_add_u32 s62, s62, s65
  s_add_u32 s62, s62, 65536
  s_lshl_b32 s63, s64, 12
  s_lshl_b32 s65, s6, 7
  s_add_u32 s63, s63, s65
  s_add_u32 s63, s63, 131072
  v_and_b32 v12, 3, v1
  v_lshlrev_b32 v10, 9, v12
  v_lshrrev_b32 v11, 2, v1
  v_lshl_add_u32 v10, v11, 3, v10
  s_mul_i32 s65, s6, 1056
  v_add_u32 v5, s65, v8
  s_mov_b32 s74, 0xaaaaaaaa
  s_mov_b32 s75, 0xaaaaaaaa
  s_mov_b32 s80, 0xcccccccc
  s_mov_b32 s81, 0xcccccccc
  v_lshrrev_b32 v11, 2, v6
  v_lshl_add_u32 v11, v7, 2, v11
  v_mul_u32_u24 v11, 1056, v11
  v_lshl_add_u32 v11, v12, 3, v11
  s_lshl_b32 s65, s6, 8
  s_add_u32 s65, s65, 26368
  v_add_u32 v11, s65, v11
  v_add_u32 v12, 67584, v11
  s_cmp_lg_u32 s3, 0
  s_cbranch_scc1 L_N_noep
L_ge_79:
  s_mov_b64 exec, 1
  buffer_load_dword v4, v2, s[56:59], 0 offen offset:128 sc1
  s_waitcnt vmcnt(0)
  v_readfirstlane_b32 s88, v4
  s_mov_b64 exec, -1
  s_cmp_lg_u32 s88, 0
  s_nop 1
  s_cbranch_scc1 L_ged_80
  s_sleep 1
  s_sub_u32 s7, s7, 1
  s_cbranch_scc0 L_ge_79
  s_branch L_exit
L_ged_80:
  s_not_b32 s89, s88
  v_mov_b32 v4, s88
  ds_write_b32 v2, v4 offset:26304
  s_nop 0
L_N_noep:
  s_waitcnt vmcnt(0)
  s_mov_b64 exec, 1
  ds_add_u32 v13, v3 offset:26224
  ds_add_u32 v2, v3 offset:26124
  ds_add_u32 v2, v3 offset:26308
  s_mov_b64 exec, -1
L_wc_81:
  ds_read_b32 v4, v2 offset:26308
  s_waitcnt lgkmcnt(0)
  v_readfirstlane_b32 s68, v4
  s_cmp_ge_u32 s68, 4
  s_nop 2
  s_cbranch_scc1 L_wcd_82
  s_sleep 1
  s_sub_u32 s7, s7, 1
  s_cbranch_scc0 L_wc_81
  s_branch L_exit
L_wcd_82:
  ds_read_b64_tr_b16 v[64:65], v11 offset:0
  ds_read_b64_tr_b16 v[68:69], v11 offset:32
  ds_read_b64_tr_b16 v[72:73], v11 offset:64
  ds_read_b64_tr_b16 v[76:77], v11 offset:96
  ds_read_b64_tr_b16 v[80:81], v11 offset:128
  ds_read_b64_tr_b16 v[84:85], v11 offset:160
  ds_read_b64_tr_b16 v[88:89], v11 offset:192
  ds_read_b64_tr_b16 v[92:93], v11 offset:224
  ds_read_b64_tr_b16 v[96:97], v11 offset:33792
  ds_read_b64_tr_b16 v[100:101], v11 offset:33824
  ds_read_b64_tr_b16 v[104:105], v11 offset:33856
  ds_read_b64_tr_b16 v[108:109], v11 offset:33888
  ds_read_b64_tr_b16 v[112:113], v11 offset:33920
  ds_read_b64_tr_b16 v[116:117], v11 offset:33952
  ds_read_b64_tr_b16 v[120:121], v11 offset:33984
  ds_read_b64_tr_b16 v[124:125], v11 offset:34016
  ds_read_b64_tr_b16 v[128:129], v12 offset:0
  ds_read_b64_tr_b16 v[132:133], v12 offset:32
  ds_read_b64_tr_b16 v[136:137], v12 offset:64
  ds_read_b64_tr_b16 v[140:141], v12 offset:96
  ds_read_b64_tr_b16 v[144:145], v12 offset:128
  ds_read_b64_tr_b16 v[148:149], v12 offset:160
  ds_read_b64_tr_b16 v[152:153], v12 offset:192
  ds_read_b64_tr_b16 v[156:157], v12 offset:224
  ds_read_b64_tr_b16 v[160:161], v12 offset:33792
  ds_read_b64_tr_b16 v[164:165], v12 offset:33824
  ds_read_b64_tr_b16 v[168:169], v12 offset:33856
  ds_read_b64_tr_b16 v[172:173], v12 offset:33888
  ds_read_b64_tr_b16 v[176:177], v12 offset:33920
  ds_read_b64_tr_b16 v[180:181], v12 offset:33952
  ds_read_b64_tr_b16 v[184:185], v12 offset:33984
  ds_read_b64_tr_b16 v[188:189], v12 offset:34016
  ds_add_u32 v15, v3 offset:26312
  s_cmp_lg_u32 s3, 0
  s_cbranch_scc1 L_N_nos
  ds_read_b32 v233, v2 offset:26304
  s_lshl_b32 s66, s47, 7
  s_add_u32 s66, s66, 32768
  v_lshlrev_b32 v232, 2, v1
  s_mov_b32 s100, 0
  s_lshl_b32 s64, s6, 1
  s_lshl_b32 s78, 3, s64
  s_mov_b32 s78, 255
  s_mov_b32 s79, 0
  s_waitcnt lgkmcnt(0)
  v_readfirstlane_b32 s88, v233
  s_nop 4
L_qaw:
  s_mov_b64 exec, s[78:79]
  v_mov_b32 v233, 0
  buffer_atomic_or v233, v232, s[8:11], s66 offen sc0 sc1
  s_mov_b64 exec, -1
  ds_read_b32 v4, v2 offset:26124
  s_waitcnt lgkmcnt(0)
  v_readfirstlane_b32 s68, v4
  s_or_b32 s68, s68, s100
  s_cmp_lg_u32 s68, 8
  s_nop 1
  s_cbranch_scc1 L_qaw_n
  s_call_b64 s[82:83], L_pvfrags
L_qaw_n:
  s_waitcnt vmcnt(0)
  v_cmp_ne_u32 vcc, s88, v233
  s_and_b64 vcc, vcc, s[78:79]
  s_cbranch_scc0 L_qaw_d
  s_sleep 1
  s_sub_u32 s7, s7, 1
  s_cbranch_scc0 L_qaw
  s_branch L_exit
L_qaw_d:
  ds_add_u32 v15, v3 offset:26212
  s_branch L_qaw_go
  s_cmp_lg_u32 s3, 0
  s_cbranch_scc1 L_N_nos
  s_lshl_b32 s66, s47, 7
  s_add_u32 s66, s66, 32768
  v_lshlrev_b32 v232, 2, v1
  s_mov_b64 exec, 255
  s_nop 0
L_qs_83:
  v_mov_b32 v233, 0
  buffer_atomic_or v233, v232, s[8:11], s66 offen sc0 sc1
  s_waitcnt vmcnt(0)
  v_cmp_ne_u32 vcc, s88, v233
  s_nop 0
  s_cbranch_vccz L_qd_84
  s_sleep 1
  s_sub_u32 s7, s7, 1
  s_cbranch_scc0 L_qs_83
  s_branch L_exit
L_qd_84:
  s_mov_b64 exec, -1
  ds_add_u32 v15, v3 offset:26212
L_N_nos:
  s_mov_b32 s100, 0
L_ql_85:
  ds_read_b32 v4, v2 offset:26124
  ds_read_b32 v232, v2 offset:26212
  ds_read_b32 v233, v2 offset:26304
  s_waitcnt lgkmcnt(0)
  v_readfirstlane_b32 s68, v4
  v_readfirstlane_b32 s69, v232
  v_readfirstlane_b32 s88, v233
  s_cmp_lg_u32 s69, 0
  s_nop 2
  s_cbranch_scc1 L_qf_87
  s_or_b32 s68, s68, s100
  s_cmp_lg_u32 s68, 8
  s_cbranch_scc1 L_qk_86
  s_call_b64 s[82:83], L_pvfrags
L_qk_86:
  s_sleep 1
  s_sub_u32 s7, s7, 1
  s_cbranch_scc0 L_ql_85
  s_branch L_exit
L_qf_87:
L_qaw_go:
  s_add_u32 s66, s62, 0
  buffer_load_dwordx4 v[192:195], v8, s[8:11], s66 offen sc1
  s_add_u32 s66, s62, 4096
  buffer_load_dwordx4 v[196:199], v8, s[8:11], s66 offen sc1
  s_add_u32 s66, s62, 8192
  buffer_load_dwordx4 v[200:203], v8, s[8:11], s66 offen sc1
  s_add_u32 s66, s62, 12288
  buffer_load_dwordx4 v[204:207], v8, s[8:11], s66 offen sc1
  buffer_load_dwordx2 v[208:209], v10, s[8:11], s63 offen offset:0 sc1
  s_add_u32 s66, s62, 16384
  buffer_load_dwordx4 v[212:215], v8, s[8:11], s66 offen sc1
  s_add_u32 s66, s62, 20480
  buffer_load_dwordx4 v[216:219], v8, s[8:11], s66 offen sc1
  s_add_u32 s66, s62, 24576
  buffer_load_dwordx4 v[220:223], v8, s[8:11], s66 offen sc1
  s_add_u32 s66, s62, 28672
  buffer_load_dwordx4 v[224:227], v8, s[8:11], s66 offen sc1
  buffer_load_dwordx2 v[228:229], v10, s[8:11], s63 offen offset:2048 sc1
  s_not_b32 s89, s88
  s_mov_b32 s69, 2
L_qi_88:
  s_cmp_lg_u32 s100, 0
  s_cbranch_scc1 L_qj_89
  ds_read_b32 v4, v2 offset:26124
  s_waitcnt lgkmcnt(0)
  v_readfirstlane_b32 s68, v4
  s_sub_u32 s69, s69, 1
  s_nop 2
  s_cbranch_scc1 L_qj_89
  s_cmp_lg_u32 s68, 8
  s_cbranch_scc1 L_qi_88
  s_call_b64 s[82:83], L_pvfrags
L_qj_89:
L_wc_90:
  ds_read_b32 v4, v2 offset:26312
  s_waitcnt lgkmcnt(0)
  v_readfirstlane_b32 s68, v4
  s_cmp_ge_u32 s68, 8
  s_nop 2
  s_cbranch_scc1 L_wcd_91
  s_sub_u32 s7, s7, 1
  s_cbranch_scc0 L_wc_90
  s_branch L_exit
L_wcd_91:
  s_waitcnt vmcnt(5)
L_qv_92:
  ds_write_b128 v5, v[192:195] offset:0
  ds_write_b128 v5, v[196:199] offset:4224
  ds_write_b128 v5, v[200:203] offset:8448
  ds_write_b128 v5, v[204:207] offset:12672
  v_xor_b32 v232, v192, v194
  v_xor_b32 v233, v196, v198
  v_xor_b32 v234, v200, v202
  v_xor_b32 v235, v204, v206
  v_xor_b32 v236, v193, v195
  v_xor_b32 v237, v197, v199
  v_xor_b32 v238, v201, v203
  v_xor_b32 v239, v205, v207
  v_cndmask_b32 v240, v232, v233, s[74:75]
  v_cndmask_b32 v241, v233, v232, s[74:75]
  v_cndmask_b32 v242, v234, v235, s[74:75]
  v_cndmask_b32 v243, v235, v234, s[74:75]
  v_cndmask_b32 v244, v236, v237, s[74:75]
  v_cndmask_b32 v245, v237, v236, s[74:75]
  v_cndmask_b32 v246, v238, v239, s[74:75]
  v_cndmask_b32 v247, v239, v238, s[74:75]
  v_xor_b32_dpp v240, v241, v240 quad_perm:[1,0,3,2] row_mask:0xf bank_mask:0xf
  v_xor_b32_dpp v242, v243, v242 quad_perm:[1,0,3,2] row_mask:0xf bank_mask:0xf
  v_xor_b32_dpp v244, v245, v244 quad_perm:[1,0,3,2] row_mask:0xf bank_mask:0xf
  v_xor_b32_dpp v246, v247, v246 quad_perm:[1,0,3,2] row_mask:0xf bank_mask:0xf
  v_cndmask_b32 v232, v240, v242, s[80:81]
  v_cndmask_b32 v233, v242, v240, s[80:81]
  v_cndmask_b32 v236, v244, v246, s[80:81]
  v_cndmask_b32 v237, v246, v244, s[80:81]
  v_xor_b32 v232, v232, v208
  v_xor_b32 v236, v236, v209
  s_nop 0
  v_xor_b32_dpp v248, v233, v232 quad_perm:[2,3,0,1] row_mask:0xf bank_mask:0xf
  v_xor_b32_dpp v249, v237, v236 quad_perm:[2,3,0,1] row_mask:0xf bank_mask:0xf
  v_cmp_ne_u64 vcc, s[88:89], v[248:249]
  s_wqm_b64 exec, vcc
  s_cbranch_execz L_qvd_93
  s_add_u32 s66, s62, 0
  buffer_load_dwordx4 v[192:195], v8, s[8:11], s66 offen sc1
  s_add_u32 s66, s62, 4096
  buffer_load_dwordx4 v[196:199], v8, s[8:11], s66 offen sc1
  s_add_u32 s66, s62, 8192
  buffer_load_dwordx4 v[200:203], v8, s[8:11], s66 offen sc1
  s_add_u32 s66, s62, 12288
  buffer_load_dwordx4 v[204:207], v8, s[8:11], s66 offen sc1
  buffer_load_dwordx2 v[208:209], v10, s[8:11], s63 offen offset:0 sc1
  s_waitcnt vmcnt(0)
  s_sub_u32 s7, s7, 1
  s_cbranch_scc0 L_qv_92
  s_branch L_exit
L_qvd_93:
  s_mov_b64 exec, -1
  ds_add_u32 v15, v3 offset:26132
  s_waitcnt vmcnt(0)
L_qv_94:
  ds_write_b128 v5, v[212:215] offset:26368
  ds_write_b128 v5, v[216:219] offset:30592
  ds_write_b128 v5, v[220:223] offset:34816
  ds_write_b128 v5, v[224:227] offset:39040
  v_xor_b32 v232, v212, v214
  v_xor_b32 v233, v216, v218
  v_xor_b32 v234, v220, v222
  v_xor_b32 v235, v224, v226
  v_xor_b32 v236, v213, v215
  v_xor_b32 v237, v217, v219
  v_xor_b32 v238, v221, v223
  v_xor_b32 v239, v225, v227
  v_cndmask_b32 v240, v232, v233, s[74:75]
  v_cndmask_b32 v241, v233, v232, s[74:75]
  v_cndmask_b32 v242, v234, v235, s[74:75]
  v_cndmask_b32 v243, v235, v234, s[74:75]
  v_cndmask_b32 v244, v236, v237, s[74:75]
  v_cndmask_b32 v245, v237, v236, s[74:75]
  v_cndmask_b32 v246, v238, v239, s[74:75]
  v_cndmask_b32 v247, v239, v238, s[74:75]
  v_xor_b32_dpp v240, v241, v240 quad_perm:[1,0,3,2] row_mask:0xf bank_mask:0xf
  v_xor_b32_dpp v242, v243, v242 quad_perm:[1,0,3,2] row_mask:0xf bank_mask:0xf
  v_xor_b32_dpp v244, v245, v244 quad_perm:[1,0,3,2] row_mask:0xf bank_mask:0xf
  v_xor_b32_dpp v246, v247, v246 quad_perm:[1,0,3,2] row_mask:0xf bank_mask:0xf
  v_cndmask_b32 v232, v240, v242, s[80:81]
  v_cndmask_b32 v233, v242, v240, s[80:81]
  v_cndmask_b32 v236, v244, v246, s[80:81]
  v_cndmask_b32 v237, v246, v244, s[80:81]
  v_xor_b32 v232, v232, v228
  v_xor_b32 v236, v236, v229
  s_nop 0
  v_xor_b32_dpp v248, v233, v232 quad_perm:[2,3,0,1] row_mask:0xf bank_mask:0xf
  v_xor_b32_dpp v249, v237, v236 quad_perm:[2,3,0,1] row_mask:0xf bank_mask:0xf
  v_cmp_ne_u64 vcc, s[88:89], v[248:249]
  s_wqm_b64 exec, vcc
  s_cbranch_execz L_qvd_95
  s_add_u32 s66, s62, 16384
  buffer_load_dwordx4 v[212:215], v8, s[8:11], s66 offen sc1
  s_add_u32 s66, s62, 20480
  buffer_load_dwordx4 v[216:219], v8, s[8:11], s66 offen sc1
  s_add_u32 s66, s62, 24576
  buffer_load_dwordx4 v[220:223], v8, s[8:11], s66 offen sc1
  s_add_u32 s66, s62, 28672
  buffer_load_dwordx4 v[224:227], v8, s[8:11], s66 offen sc1
  buffer_load_dwordx2 v[228:229], v10, s[8:11], s63 offen offset:2048 sc1
  s_waitcnt vmcnt(0)
  s_sub_u32 s7, s7, 1
  s_cbranch_scc0 L_qv_94
  s_branch L_exit
L_qvd_95:
  s_mov_b64 exec, -1
  ds_add_u32 v15, v3 offset:26220
  s_cmp_lg_u32 s100, 0
  s_cbranch_scc1 L_qm_96
L_wc_97:
  ds_read_b32 v4, v2 offset:26124
  s_waitcnt lgkmcnt(0)
  v_readfirstlane_b32 s68, v4
  s_cmp_ge_u32 s68, 8
  s_nop 2
  s_cbranch_scc1 L_wcd_98
  s_sub_u32 s7, s7, 1
  s_cbranch_scc0 L_wc_97
  s_branch L_exit
L_wcd_98:
  s_call_b64 s[82:83], L_pvfrags
L_qm_96:
L_wc_99:
  ds_read_b32 v4, v2 offset:26128
  s_waitcnt lgkmcnt(0)
  v_readfirstlane_b32 s68, v4
  s_cmp_ge_u32 s68, 8
  s_nop 2
  s_cbranch_scc1 L_wcd_100
  s_sleep 1
  s_sub_u32 s7, s7, 1
  s_cbranch_scc0 L_wc_99
  s_branch L_exit
L_wcd_100:
  s_branch L_pvf_end
L_pvfrags:
  s_mov_b32 s100, 16
  ds_read_b64_tr_b16 v[66:67], v11 offset:16896
  ds_read_b64_tr_b16 v[70:71], v11 offset:16928
  ds_read_b64_tr_b16 v[74:75], v11 offset:16960
  ds_read_b64_tr_b16 v[78:79], v11 offset:16992
  ds_read_b64_tr_b16 v[82:83], v11 offset:17024
  ds_read_b64_tr_b16 v[86:87], v11 offset:17056
  ds_read_b64_tr_b16 v[90:91], v11 offset:17088
  ds_read_b64_tr_b16 v[94:95], v11 offset:17120
  ds_read_b64_tr_b16 v[98:99], v11 offset:50688
  ds_read_b64_tr_b16 v[102:103], v11 offset:50720
  ds_read_b64_tr_b16 v[106:107], v11 offset:50752
  ds_read_b64_tr_b16 v[110:111], v11 offset:50784
  ds_read_b64_tr_b16 v[114:115], v11 offset:50816
  ds_read_b64_tr_b16 v[118:119], v11 offset:50848
  ds_read_b64_tr_b16 v[122:123], v11 offset:50880
  ds_read_b64_tr_b16 v[126:127], v11 offset:50912
  ds_read_b64_tr_b16 v[130:131], v12 offset:16896
  ds_read_b64_tr_b16 v[134:135], v12 offset:16928
  ds_read_b64_tr_b16 v[138:139], v12 offset:16960
  ds_read_b64_tr_b16 v[142:143], v12 offset:16992
  ds_read_b64_tr_b16 v[146:147], v12 offset:17024
  ds_read_b64_tr_b16 v[150:151], v12 offset:17056
  ds_read_b64_tr_b16 v[154:155], v12 offset:17088
  ds_read_b64_tr_b16 v[158:159], v12 offset:17120
  ds_read_b64_tr_b16 v[162:163], v12 offset:50688
  ds_read_b64_tr_b16 v[166:167], v12 offset:50720
  ds_read_b64_tr_b16 v[170:171], v12 offset:50752
  ds_read_b64_tr_b16 v[174:175], v12 offset:50784
  ds_read_b64_tr_b16 v[178:179], v12 offset:50816
  ds_read_b64_tr_b16 v[182:183], v12 offset:50848
  ds_read_b64_tr_b16 v[186:187], v12 offset:50880
  ds_read_b64_tr_b16 v[190:191], v12 offset:50912
  ds_add_u32 v15, v3 offset:26128
  s_setpc_b64 s[82:83]
L_pvf_end:
  s_mov_b32 s76, 0x800080
  s_lshr_b32 s64, s6, 1
  s_lshl_b32 s66, s64, 2
  v_mov_b32 v10, 0x7ff00000
  v_writelane_b32 v10, s66, 0
  s_mul_i32 s64, s64, 9472
  s_add_u32 s64, s64, 60160
  s_and_b32 s65, s6, 1
  s_lshl_b32 s66, s65, 8
  s_add_u32 s66, s66, s64
  v_mul_u32_u24 v11, 592, v6
  v_lshl_add_u32 v9, v7, 4, v11
  v_add_u32 v9, s66, v9
  s_mov_b32 s48, s34
  s_mov_b32 s49, s35
  s_mov_b32 s50, 1835008
  s_mov_b32 s51, 0x00020000
  s_cmp_ge_u32 s91, 14
  s_cbranch_scc1 L_nowdt
  s_lshl_b32 s64, s95, 14
  s_lshl_b32 s65, s6, 12
  s_add_u32 s64, s64, s65
  v_lshlrev_b32 v60, 7, v1
  s_mov_b32 exec_hi, 0
  s_mov_b32 s48, s30
  s_mov_b32 s49, s31
  s_mov_b32 s50, 1835008
  s_mov_b32 s51, 0x00020000
  s_and_b32 s64, s95, 3
  s_lshl_b32 s65, s6, 2
  s_add_u32 s64, s64, s65
  s_mul_i32 s64, s64, 114688
  s_lshl_b32 s65, s95, 5
  s_add_u32 s64, s64, s65
  v_mul_u32_u24 v60, 3584, v1
  s_mov_b32 exec_lo, -1
  buffer_load_dword v62, v60, s[48:51], s64 offen
  s_mov_b64 exec, -1
  s_branch L_wdtd
L_nowdt:
  s_mov_b32 s48, s30
  s_mov_b32 s49, s31
  s_mov_b32 s50, 1835008
  s_mov_b32 s51, 0x00020000
  s_mov_b32 s52, s32
  s_mov_b32 s53, s33
  s_mov_b32 s54, 1835008
  s_mov_b32 s55, 0x00020000
  s_and_b32 s65, s4, 1
  s_lshl_b32 s65, s65, 4
  s_sub_u32 s66, s95, s65
  s_and_b32 s64, s66, 3
  s_lshl_b32 s65, s6, 2
  s_add_u32 s64, s64, s65
  s_mul_i32 s64, s64, 114688
  s_lshl_b32 s65, s66, 5
  s_add_u32 s64, s64, s65
  v_mul_u32_u24 v60, 3584, v1
  s_mov_b32 exec_hi, 0
  buffer_load_dword v62, v60, s[48:51], s64 offen
  s_mov_b32 exec_lo, -1
  buffer_load_dword v63, v60, s[52:55], s64 offen
  s_mov_b64 exec, -1
L_wdtd:
  s_mov_b32 s76, 3137339392
  s_setprio 1
L_wc_101:
  ds_read_b32 v4, v2 offset:26136
  ds_read_b128 v[48:51], v14 offset:25088
  s_waitcnt lgkmcnt(0)
  v_readfirstlane_b32 s68, v4
  s_cmp_ge_u32 s68, 4
  s_nop 2
  s_cbranch_scc1 L_wcd_102
  s_sleep 1
  s_sub_u32 s7, s7, 1
  s_cbranch_scc0 L_wc_101
  s_branch L_exit
L_wcd_102:
  v_max3_f32 v52, v48, v49, v50
  v_max_f32 v52, v52, v51
  v_mul_f32 v52, s76, v52
  v_fma_f32 v48, v48, s76, -v52
  v_fma_f32 v49, v49, s76, -v52
  v_fma_f32 v50, v50, s76, -v52
  v_fma_f32 v51, v51, s76, -v52
  v_cvt_pknorm_u16_f32 v56, v48, v49
  v_cvt_pknorm_u16_f32 v57, v50, v51
  s_nop 1
L_wc_103:
  ds_read_b32 v4, v2 offset:26144
  ds_read_b128 v[16:19], v8 offset:16896
  ds_read_b128 v[20:23], v8 offset:17920
  ds_read_b128 v[24:27], v8 offset:18944
  ds_read_b128 v[28:31], v8 offset:19968
  s_waitcnt lgkmcnt(0)
  v_readfirstlane_b32 s68, v4
  s_cmp_ge_u32 s68, 4
  s_nop 2
  s_cbranch_scc1 L_wcd_104
  s_sub_u32 s7, s7, 1
  s_cbranch_scc0 L_wc_103
  s_branch L_exit
L_wcd_104:
  s_setprio 1
  v_pk_sub_u16 v16, v16, v56 op_sel:[0,0] op_sel_hi:[1,0] clamp
  v_pk_sub_u16 v17, v17, v56 op_sel:[0,0] op_sel_hi:[1,0] clamp
  v_pk_sub_u16 v18, v18, v56 op_sel:[0,0] op_sel_hi:[1,0] clamp
  v_pk_sub_u16 v19, v19, v56 op_sel:[0,0] op_sel_hi:[1,0] clamp
  s_nop 1
  v_mfma_f32_16x16x32_bf16 v[192:195], v[64:67], v[16:19], 0
  v_pk_sub_u16 v20, v20, v56 op_sel:[0,1] op_sel_hi:[1,1] clamp
  v_mfma_f32_16x16x32_bf16 v[196:199], v[68:71], v[16:19], 0
  v_pk_sub_u16 v21, v21, v56 op_sel:[0,1] op_sel_hi:[1,1] clamp
  v_mfma_f32_16x16x32_bf16 v[200:203], v[72:75], v[16:19], 0
  v_pk_sub_u16 v22, v22, v56 op_sel:[0,1] op_sel_hi:[1,1] clamp
  v_pk_sub_u16 v23, v23, v56 op_sel:[0,1] op_sel_hi:[1,1] clamp
  v_mfma_f32_16x16x32_bf16 v[204:207], v[76:79], v[16:19], 0
  s_nop 0
  v_mfma_f32_16x16x32_bf16 v[192:195], v[96:99], v[20:23], v[192:195]
  v_pk_sub_u16 v24, v24, v57 op_sel:[0,0] op_sel_hi:[1,0] clamp
  v_mfma_f32_16x16x32_bf16 v[196:199], v[100:103], v[20:23], v[196:199]
  v_pk_sub_u16 v25, v25, v57 op_sel:[0,0] op_sel_hi:[1,0] clamp
  v_mfma_f32_16x16x32_bf16 v[200:203], v[104:107], v[20:23], v[200:203]
  v_pk_sub_u16 v26, v26, v57 op_sel:[0,0] op_sel_hi:[1,0] clamp
  v_pk_sub_u16 v27, v27, v57 op_sel:[0,0] op_sel_hi:[1,0] clamp
  v_mfma_f32_16x16x32_bf16 v[204:207], v[108:111], v[20:23], v[204:207]
  s_nop 0
  v_mfma_f32_16x16x32_bf16 v[192:195], v[128:131], v[24:27], v[192:195]
  v_pk_sub_u16 v28, v28, v57 op_sel:[0,1] op_sel_hi:[1,1] clamp
  v_mfma_f32_16x16x32_bf16 v[196:199], v[132:135], v[24:27], v[196:199]
  v_pk_sub_u16 v29, v29, v57 op_sel:[0,1] op_sel_hi:[1,1] clamp
  v_mfma_f32_16x16x32_bf16 v[200:203], v[136:139], v[24:27], v[200:203]
  v_pk_sub_u16 v30, v30, v57 op_sel:[0,1] op_sel_hi:[1,1] clamp
  v_pk_sub_u16 v31, v31, v57 op_sel:[0,1] op_sel_hi:[1,1] clamp
  v_mfma_f32_16x16x32_bf16 v[204:207], v[140:143], v[24:27], v[204:207]
  s_nop 0
  v_mfma_f32_16x16x32_bf16 v[192:195], v[160:163], v[28:31], v[192:195]
  v_mfma_f32_16x16x32_bf16 v[196:199], v[164:167], v[28:31], v[196:199]
  ds_read_b32 v4, v2 offset:26148
  v_mfma_f32_16x16x32_bf16 v[200:203], v[168:171], v[28:31], v[200:203]
  ds_read_b128 v[48:51], v14 offset:25344
  v_mfma_f32_16x16x32_bf16 v[204:207], v[172:175], v[28:31], v[204:207]
  ds_read_b128 v[32:35], v8 offset:20992
  v_mfma_f32_16x16x32_bf16 v[208:211], v[80:83], v[16:19], 0
  ds_read_b128 v[36:39], v8 offset:22016
  v_mfma_f32_16x16x32_bf16 v[212:215], v[84:87], v[16:19], 0
  ds_read_b128 v[40:43], v8 offset:23040
  v_cvt_pk_bf16_f32 v192, v192, v193
  v_mfma_f32_16x16x32_bf16 v[208:211], v[112:115], v[20:23], v[208:211]
  ds_read_b128 v[44:47], v8 offset:24064
  v_cvt_pk_bf16_f32 v193, v194, v195
  v_mfma_f32_16x16x32_bf16 v[212:215], v[116:119], v[20:23], v[212:215]
  v_cvt_pk_bf16_f32 v194, v196, v197
  v_cvt_pk_bf16_f32 v195, v198, v199
  v_mfma_f32_16x16x32_bf16 v[208:211], v[144:147], v[24:27], v[208:211]
  ds_write_b128 v9, v[192:195] offset:0
  v_cvt_pk_bf16_f32 v200, v200, v201
  v_mfma_f32_16x16x32_bf16 v[212:215], v[148:151], v[24:27], v[212:215]
  v_cvt_pk_bf16_f32 v201, v202, v203
  v_cvt_pk_bf16_f32 v202, v204, v205
  v_mfma_f32_16x16x32_bf16 v[208:211], v[176:179], v[28:31], v[208:211]
  v_cvt_pk_bf16_f32 v203, v206, v207
  v_mfma_f32_16x16x32_bf16 v[212:215], v[180:183], v[28:31], v[212:215]
  ds_write_b128 v9, v[200:203] offset:64
  v_mfma_f32_16x16x32_bf16 v[216:219], v[88:91], v[16:19], 0
  ds_add_u32 v10, v3 offset:26320
  s_waitcnt lgkmcnt(7)
  v_mfma_f32_16x16x32_bf16 v[220:223], v[92:95], v[16:19], 0
  v_readfirstlane_b32 s68, v4
  v_mfma_f32_16x16x32_bf16 v[216:219], v[120:123], v[20:23], v[216:219]
  s_cmp_ge_u32 s68, 4
  s_cbranch_scc1 L_pbk_106
L_psl_105:
  ds_read_b32 v4, v2 offset:26148
  ds_read_b128 v[48:51], v14 offset:25344
  ds_read_b128 v[32:35], v8 offset:20992
  ds_read_b128 v[36:39], v8 offset:22016
  ds_read_b128 v[40:43], v8 offset:23040
  ds_read_b128 v[44:47], v8 offset:24064
  s_waitcnt lgkmcnt(0)
  v_readfirstlane_b32 s68, v4
  s_cmp_ge_u32 s68, 4
  s_nop 2
  s_cbranch_scc1 L_pbk_106
  s_sub_u32 s7, s7, 1
  s_cbranch_scc0 L_psl_105
  s_branch L_exit
L_pbk_106:
  v_max3_f32 v52, v48, v49, v50
  v_mfma_f32_16x16x32_bf16 v[220:223], v[124:127], v[20:23], v[220:223]
  v_max_f32 v52, v52, v51
  v_mul_f32 v52, s76, v52
  v_mfma_f32_16x16x32_bf16 v[216:219], v[152:155], v[24:27], v[216:219]
  v_fma_f32 v48, v48, s76, -v52
  v_fma_f32 v49, v49, s76, -v52
  v_mfma_f32_16x16x32_bf16 v[220:223], v[156:159], v[24:27], v[220:223]
  v_fma_f32 v50, v50, s76, -v52
  v_fma_f32 v51, v51, s76, -v52
  v_mfma_f32_16x16x32_bf16 v[216:219], v[184:187], v[28:31], v[216:219]
  v_cvt_pknorm_u16_f32 v56, v48, v49
  v_cvt_pknorm_u16_f32 v57, v50, v51
  v_mfma_f32_16x16x32_bf16 v[220:223], v[188:191], v[28:31], v[220:223]
  s_waitcnt lgkmcnt(3)
  v_pk_sub_u16 v32, v32, v56 op_sel:[0,0] op_sel_hi:[1,0] clamp
  v_pk_sub_u16 v33, v33, v56 op_sel:[0,0] op_sel_hi:[1,0] clamp
  v_pk_sub_u16 v34, v34, v56 op_sel:[0,0] op_sel_hi:[1,0] clamp
  v_pk_sub_u16 v35, v35, v56 op_sel:[0,0] op_sel_hi:[1,0] clamp
  s_nop 1
  v_mfma_f32_16x16x32_bf16 v[224:227], v[64:67], v[32:35], 0
  v_cvt_pk_bf16_f32 v208, v208, v209
  v_cvt_pk_bf16_f32 v209, v210, v211
  v_mfma_f32_16x16x32_bf16 v[228:231], v[68:71], v[32:35], 0
  v_cvt_pk_bf16_f32 v210, v212, v213
  v_cvt_pk_bf16_f32 v211, v214, v215
  v_mfma_f32_16x16x32_bf16 v[232:235], v[72:75], v[32:35], 0
  ds_write_b128 v9, v[208:211] offset:128
  v_pk_sub_u16 v36, v36, v56 op_sel:[0,1] op_sel_hi:[1,1] clamp
  v_mfma_f32_16x16x32_bf16 v[236:239], v[76:79], v[32:35], 0
  v_pk_sub_u16 v37, v37, v56 op_sel:[0,1] op_sel_hi:[1,1] clamp
  v_pk_sub_u16 v38, v38, v56 op_sel:[0,1] op_sel_hi:[1,1] clamp
  v_pk_sub_u16 v39, v39, v56 op_sel:[0,1] op_sel_hi:[1,1] clamp
  s_nop 1
  v_mfma_f32_16x16x32_bf16 v[224:227], v[96:99], v[36:39], v[224:227]
  v_cvt_pk_bf16_f32 v216, v216, v217
  v_cvt_pk_bf16_f32 v217, v218, v219
  v_mfma_f32_16x16x32_bf16 v[228:231], v[100:103], v[36:39], v[228:231]
  v_cvt_pk_bf16_f32 v218, v220, v221
  v_cvt_pk_bf16_f32 v219, v222, v223
  v_mfma_f32_16x16x32_bf16 v[232:235], v[104:107], v[36:39], v[232:235]
  ds_write_b128 v9, v[216:219] offset:192
  v_pk_sub_u16 v40, v40, v57 op_sel:[0,0] op_sel_hi:[1,0] clamp
  v_mfma_f32_16x16x32_bf16 v[236:239], v[108:111], v[36:39], v[236:239]
  v_pk_sub_u16 v41, v41, v57 op_sel:[0,0] op_sel_hi:[1,0] clamp
  v_pk_sub_u16 v42, v42, v57 op_sel:[0,0] op_sel_hi:[1,0] clamp
  v_pk_sub_u16 v43, v43, v57 op_sel:[0,0] op_sel_hi:[1,0] clamp
  s_nop 1
  v_mfma_f32_16x16x32_bf16 v[224:227], v[128:131], v[40:43], v[224:227]
  ds_add_u32 v10, v3 offset:26328
  v_pk_sub_u16 v44, v44, v57 op_sel:[0,1] op_sel_hi:[1,1] clamp
  v_mfma_f32_16x16x32_bf16 v[228:231], v[132:135], v[40:43], v[228:231]
  v_pk_sub_u16 v45, v45, v57 op_sel:[0,1] op_sel_hi:[1,1] clamp
  v_pk_sub_u16 v46, v46, v57 op_sel:[0,1] op_sel_hi:[1,1] clamp
  v_mfma_f32_16x16x32_bf16 v[232:235], v[136:139], v[40:43], v[232:235]
  v_pk_sub_u16 v47, v47, v57 op_sel:[0,1] op_sel_hi:[1,1] clamp
  v_mfma_f32_16x16x32_bf16 v[236:239], v[140:143], v[40:43], v[236:239]
  s_nop 0
  v_mfma_f32_16x16x32_bf16 v[224:227], v[160:163], v[44:47], v[224:227]
  v_mfma_f32_16x16x32_bf16 v[228:231], v[164:167], v[44:47], v[228:231]
  v_mfma_f32_16x16x32_bf16 v[232:235], v[168:171], v[44:47], v[232:235]
  v_mfma_f32_16x16x32_bf16 v[236:239], v[172:175], v[44:47], v[236:239]
  v_mfma_f32_16x16x32_bf16 v[240:243], v[80:83], v[32:35], 0
  v_mfma_f32_16x16x32_bf16 v[244:247], v[84:87], v[32:35], 0
  s_nop 2
  v_cvt_pk_bf16_f32 v224, v224, v225
  v_cvt_pk_bf16_f32 v225, v226, v227
  v_mfma_f32_16x16x32_bf16 v[240:243], v[112:115], v[36:39], v[240:243]
  v_cvt_pk_bf16_f32 v226, v228, v229
  v_cvt_pk_bf16_f32 v227, v230, v231
  v_mfma_f32_16x16x32_bf16 v[244:247], v[116:119], v[36:39], v[244:247]
  ds_write_b128 v9, v[224:227] offset:18944
  v_cvt_pk_bf16_f32 v232, v232, v233
  v_mfma_f32_16x16x32_bf16 v[240:243], v[144:147], v[40:43], v[240:243]
  v_cvt_pk_bf16_f32 v233, v234, v235
  v_cvt_pk_bf16_f32 v234, v236, v237
  v_mfma_f32_16x16x32_bf16 v[244:247], v[148:151], v[40:43], v[244:247]
  v_cvt_pk_bf16_f32 v235, v238, v239
  v_mfma_f32_16x16x32_bf16 v[240:243], v[176:179], v[44:47], v[240:243]
  ds_write_b128 v9, v[232:235] offset:19008
  v_mfma_f32_16x16x32_bf16 v[244:247], v[180:183], v[44:47], v[244:247]
  ds_add_u32 v10, v3 offset:26336
  v_mfma_f32_16x16x32_bf16 v[248:251], v[88:91], v[32:35], 0
  v_mfma_f32_16x16x32_bf16 v[252:255], v[92:95], v[32:35], 0
  v_mfma_f32_16x16x32_bf16 v[248:251], v[120:123], v[36:39], v[248:251]
  s_nop 1
  v_cvt_pk_bf16_f32 v240, v240, v241
  v_cvt_pk_bf16_f32 v241, v242, v243
  v_mfma_f32_16x16x32_bf16 v[252:255], v[124:127], v[36:39], v[252:255]
  v_cvt_pk_bf16_f32 v242, v244, v245
  v_cvt_pk_bf16_f32 v243, v246, v247
  v_mfma_f32_16x16x32_bf16 v[248:251], v[152:155], v[40:43], v[248:251]
  ds_write_b128 v9, v[240:243] offset:19072
  v_mfma_f32_16x16x32_bf16 v[252:255], v[156:159], v[40:43], v[252:255]
  v_mfma_f32_16x16x32_bf16 v[248:251], v[184:187], v[44:47], v[248:251]
  v_mfma_f32_16x16x32_bf16 v[252:255], v[188:191], v[44:47], v[252:255]
  s_nop 6
  v_cvt_pk_bf16_f32 v248, v248, v249
  v_cvt_pk_bf16_f32 v249, v250, v251
  v_cvt_pk_bf16_f32 v250, v252, v253
  v_cvt_pk_bf16_f32 v251, v254, v255
  ds_write_b128 v9, v[248:251] offset:19136
  ds_add_u32 v10, v3 offset:26344
  s_setprio 0
  s_cmp_ge_u32 s91, 14
  s_cbranch_scc1 L_RS
  s_mov_b32 s48, s30
  s_mov_b32 s49, s31
  s_mov_b32 s50, 1835008
  s_mov_b32 s51, 0x00020000
  s_mov_b32 s52, s32
  s_mov_b32 s53, s33
  s_mov_b32 s54, 1835008
  s_mov_b32 s55, 0x00020000
  s_mov_b32 s60, s34
  s_mov_b32 s61, s35
  s_mov_b32 s62, 1835008
  s_mov_b32 s63, 0x00020000
L_wc_107:
  ds_read_b32 v4, v2 offset:26196
  s_waitcnt lgkmcnt(0)
  v_readfirstlane_b32 s68, v4
  s_cmp_ge_u32 s68, 4
  s_nop 2
  s_cbranch_scc1 L_wcd_108
  s_sleep 1
  s_sub_u32 s7, s7, 1
  s_cbranch_scc0 L_wc_107
  s_branch L_exit
L_wcd_108:
  v_lshrrev_b32 v9, 1, v1
  v_mul_u32_u24 v9, 3584, v9
  v_and_b32 v11, 1, v1
  v_lshl_add_u32 v9, v11, 4, v9
  s_mul_i32 s65, s6, 458752
  s_lshl_b32 s64, s95, 5
  s_add_u32 s65, s65, s64
  s_lshl_b32 s64, s6, 13
  s_add_u32 s64, s64, 121088
  s_mov_b32 m0, s64
  v_lshrrev_b32 v12, 2, v6
  v_lshl_add_u32 v12, v7, 3, v12
  v_lshlrev_b32 v12, 5, v12
  v_and_b32 v11, 3, v6
  v_lshl_add_u32 v12, v11, 3, v12
  v_add_u32 v12, s64, v12
  s_nop 1
L_wc_109:
  ds_read_b32 v4, v2 offset:26156
  s_waitcnt lgkmcnt(0)
  v_readfirstlane_b32 s68, v4
  s_cmp_ge_u32 s68, 1
  s_nop 2
  s_cbranch_scc1 L_wcd_110
  s_sleep 2
  s_sub_u32 s7, s7, 1
  s_cbranch_scc0 L_wc_109
  s_branch L_exit
L_wcd_110:
  s_add_u32 s68, s95, 0
  s_and_b32 s68, s68, 3
  s_lshl_b32 s69, s68, 11
  s_add_u32 m0, s64, s69
  s_mul_i32 s68, s68, 114688
  s_add_u32 s68, s68, s65
  buffer_load_dwordx4 v9, s[48:51], s68 offen lds
  s_addk_i32 m0, 1024
  s_nop 0
  buffer_load_dwordx4 v9, s[52:55], s68 offen lds
  v_lshlrev_b32 v11, 12, v7
  v_lshl_add_u32 v11, v6, 3, v11
  s_lshl_b32 s66, s95, 14
  s_lshl_b32 s67, s6, 8
  s_add_u32 s66, s66, s67
  buffer_load_dwordx2 v[144:145], v11, s[60:63], s66 offen offset:0
  buffer_load_dwordx2 v[160:161], v11, s[60:63], s66 offen offset:128
  buffer_load_dwordx2 v[146:147], v11, s[60:63], s66 offen offset:1024
  buffer_load_dwordx2 v[162:163], v11, s[60:63], s66 offen offset:1152
  buffer_load_dwordx2 v[148:149], v11, s[60:63], s66 offen offset:2048
  buffer_load_dwordx2 v[164:165], v11, s[60:63], s66 offen offset:2176
  buffer_load_dwordx2 v[150:151], v11, s[60:63], s66 offen offset:3072
  buffer_load_dwordx2 v[166:167], v11, s[60:63], s66 offen offset:3200
  s_add_u32 s68, s95, 1
  s_and_b32 s68, s68, 3
  s_lshl_b32 s69, s68, 11
  s_add_u32 m0, s64, s69
  s_mul_i32 s68, s68, 114688
  s_add_u32 s68, s68, s65
  buffer_load_dwordx4 v9, s[48:51], s68 offen lds
  s_addk_i32 m0, 1024
  s_nop 0
  buffer_load_dwordx4 v9, s[52:55], s68 offen lds
  s_add_u32 s68, s95, 2
  s_and_b32 s68, s68, 3
  s_lshl_b32 s69, s68, 11
  s_add_u32 m0, s64, s69
  s_mul_i32 s68, s68, 114688
  s_add_u32 s68, s68, s65
  buffer_load_dwordx4 v9, s[48:51], s68 offen lds
  s_addk_i32 m0, 1024
  s_nop 0
  buffer_load_dwordx4 v9, s[52:55], s68 offen lds
  s_add_u32 s68, s95, 3
  s_and_b32 s68, s68, 3
  s_lshl_b32 s69, s68, 11
  s_add_u32 m0, s64, s69
  s_mul_i32 s68, s68, 114688
  s_add_u32 s68, s68, s65
  buffer_load_dwordx4 v9, s[48:51], s68 offen lds
  s_addk_i32 m0, 1024
  s_nop 0
  buffer_load_dwordx4 v9, s[52:55], s68 offen lds
  ds_add_u32 v15, v3 offset:26116
  s_waitcnt vmcnt(0)
  s_lshl_b32 s66, s6, 2
  v_mov_b32 v59, s66
  s_mov_b64 exec, 1
  ds_add_u32 v59, v3 offset:26272
  s_mov_b64 exec, -1
  ds_read_b64_tr_b16 v[240:241], v12 offset:0
  ds_read_b64_tr_b16 v[242:243], v12 offset:128
  ds_read_b64_tr_b16 v[244:245], v12 offset:1024
  ds_read_b64_tr_b16 v[246:247], v12 offset:1152
  ds_read_b64_tr_b16 v[208:209], v12 offset:2048
  ds_read_b64_tr_b16 v[210:211], v12 offset:2176
  ds_read_b64_tr_b16 v[212:213], v12 offset:3072
  ds_read_b64_tr_b16 v[214:215], v12 offset:3200
  ds_read_b64_tr_b16 v[216:217], v12 offset:4096
  ds_read_b64_tr_b16 v[218:219], v12 offset:4224
  ds_read_b64_tr_b16 v[220:221], v12 offset:5120
  ds_read_b64_tr_b16 v[222:223], v12 offset:5248
  ds_read_b64_tr_b16 v[224:225], v12 offset:6144
  ds_read_b64_tr_b16 v[226:227], v12 offset:6272
  ds_read_b64_tr_b16 v[228:229], v12 offset:7168
  ds_read_b64_tr_b16 v[230:231], v12 offset:7296
  s_waitcnt vmcnt(0)
  v_perm_b32 v112, v146, v144, s86
  v_perm_b32 v116, v146, v144, s87
  v_perm_b32 v113, v150, v148, s86
  v_perm_b32 v117, v150, v148, s87
  v_perm_b32 v120, v147, v145, s86
  v_perm_b32 v124, v147, v145, s87
  v_perm_b32 v121, v151, v149, s86
  v_perm_b32 v125, v151, v149, s87
  v_perm_b32 v114, v162, v160, s86
  v_perm_b32 v118, v162, v160, s87
  v_perm_b32 v115, v166, v164, s86
  v_perm_b32 v119, v166, v164, s87
  v_perm_b32 v122, v163, v161, s86
  v_perm_b32 v126, v163, v161, s87
  v_perm_b32 v123, v167, v165, s86
  v_perm_b32 v127, v167, v165, s87
  s_nop 1
L_nof:
  v_and_b32 v11, 3, v6
  v_mul_u32_u24 v11, 1040, v11
  v_lshl_add_u32 v11, v7, 4, v11
  s_lshl_b32 s64, s6, 8
  v_add_u32 v11, s64, v11
  s_lshl_b32 s64, s6, 9
  v_lshl_add_u32 v12, v6, 4, s64
  v_lshlrev_b32 v13, 4, v6
  v_lshrrev_b32 v14, 5, v1
  v_lshl_add_u32 v13, v14, 8, v13
  v_bfe_u32 v14, v1, 4, 1
  v_lshl_add_u32 v13, v14, 2, v13
  v_lshlrev_b32 v56, 5, v14
  s_lshl_b32 s64, s6, 2
  s_add_u32 s64, s64, 10496
  v_lshl_add_u32 v62, v6, 4, s64
  v_lshlrev_b32 v63, 11, v14
  v_lshl_add_u32 v63, v6, 4, v63
  v_lshrrev_b32 v64, 5, v1
  v_lshl_add_u32 v63, v64, 8, v63
  s_lshl_b32 s64, s6, 7
  v_lshlrev_b32 v57, 6, v14
  v_lshl_add_u32 v57, v6, 1, v57
  v_add_u32 v57, s64, v57
  v_and_b32 v58, 1, v6
  v_lshlrev_b32 v58, 6, v58
  v_lshl_add_u32 v58, v7, 3, v58
  v_add_u32 v58, s64, v58
  s_lshl_b32 s63, s6, 2
  v_mov_b32 v59, s63
  s_lshl_b32 s63, s95, 12
  s_lshl_b32 s64, s6, 9
  s_add_u32 s63, s63, s64
  s_add_u32 s63, s63, 720896
  v_mov_b32 v66, s88
  v_mov_b32 v67, s89
  v_mov_b32 v70, s88
  v_mov_b32 v71, s89
  v_mov_b32 v74, s88
  v_mov_b32 v75, s89
  v_mov_b32 v78, s88
  v_mov_b32 v79, s89
  v_and_b32 v57, 3, v6
  v_lshl_add_u32 v57, v7, 2, v57
  v_lshlrev_b32 v57, 4, v57
  v_lshrrev_b32 v58, 3, v6
  v_lshl_add_u32 v13, v58, 8, v57
  v_bfe_u32 v58, v6, 2, 1
  v_lshl_add_u32 v13, v58, 2, v13
  v_lshlrev_b32 v56, 5, v58
  v_lshrrev_b32 v58, 2, v6
  v_mul_u32_u24 v58, 320, v58
  v_add_u32 v57, v57, v58
  v_mov_b32 v40, 0
  v_mov_b32 v41, 0
  v_mov_b32 v42, 0
  v_mov_b32 v43, 0
  v_mov_b32 v44, 925353388
  v_mov_b32 v45, 3222493025
  s_mov_b32 s60, 989855744
  s_mov_b32 s61, 3184710632
L_wc_111:
  ds_read_b32 v4, v2 offset:26152
  s_waitcnt lgkmcnt(0)
  v_readfirstlane_b32 s68, v4
  s_cmp_ge_u32 s68, 4
  s_nop 2
  s_cbranch_scc1 L_wcd_112
  s_sleep 2
  s_sub_u32 s7, s7, 1
  s_cbranch_scc0 L_wc_111
  s_branch L_exit
L_wcd_112:
L_wc_113:
  ds_read_b32 v4, v2 offset:26152
  ds_read_b128 v[16:19], v11 offset:0
  ds_read_b128 v[20:23], v11 offset:64
  ds_read_b128 v[24:27], v11 offset:128
  ds_read_b128 v[28:31], v11 offset:192
  s_waitcnt lgkmcnt(0)
  v_readfirstlane_b32 s68, v4
  s_cmp_ge_u32 s68, 4
  s_nop 2
  s_cbranch_scc1 L_wcd_114
  s_sub_u32 s7, s7, 1
  s_cbranch_scc0 L_wc_113
  s_branch L_exit
L_wcd_114:
  v_mfma_f32_16x16x32_bf16 v[32:35], v[16:19], v[240:243], 0
  v_mfma_f32_16x16x32_bf16 v[36:39], v[16:19], v[244:247], 0
  v_mfma_f32_16x16x32_bf16 v[32:35], v[20:23], v[208:211], v[32:35]
  v_mfma_f32_16x16x32_bf16 v[36:39], v[20:23], v[212:215], v[36:39]
  v_mfma_f32_16x16x32_bf16 v[32:35], v[24:27], v[216:219], v[32:35]
  v_mfma_f32_16x16x32_bf16 v[36:39], v[24:27], v[220:223], v[36:39]
  v_mfma_f32_16x16x32_bf16 v[32:35], v[28:31], v[224:227], v[32:35]
  v_mfma_f32_16x16x32_bf16 v[36:39], v[28:31], v[228:231], v[36:39]
  s_mov_b64 exec, 0xffff
  s_nop 5
  ds_write_b128 v12, v[32:35] offset:8448
  ds_write_b128 v12, v[36:39] offset:8704
  s_mov_b64 exec, -1
  ds_add_u32 v15, v3 offset:26160
L_wc_115:
  ds_read_b32 v4, v2 offset:26160
  ds_read_b32 v16, v13 offset:8448
  ds_read_b32 v17, v13 offset:8456
  ds_read_b32 v18, v13 offset:8960
  ds_read_b32 v19, v13 offset:8968
  ds_read_b32 v20, v13 offset:9472
  ds_read_b32 v21, v13 offset:9480
  ds_read_b32 v22, v13 offset:9984
  ds_read_b32 v23, v13 offset:9992
  s_waitcnt lgkmcnt(0)
  v_readfirstlane_b32 s68, v4
  s_cmp_ge_u32 s68, 4
  s_nop 2
  s_cbranch_scc1 L_wcd_116
  s_sub_u32 s7, s7, 1
  s_cbranch_scc0 L_wc_115
  s_branch L_exit
L_wcd_116:
  v_pk_add_f32 v[16:17], v[16:17], v[18:19]
  v_pk_add_f32 v[20:21], v[20:21], v[22:23]
  v_pk_add_f32 v[60:61], v[16:17], v[20:21]
  s_waitcnt lgkmcnt(0)
  s_barrier
  ds_read_b128 v[24:27], v56 offset:8320
  ds_read_b128 v[28:31], v56 offset:8336
  ds_read_b128 v[16:19], v57 offset:10496
  s_waitcnt lgkmcnt(1)
  v_pk_add_f32 v[24:25], v[24:25], v[26:27]
  v_pk_add_f32 v[28:29], v[28:29], v[30:31]
  v_pk_add_f32 v[24:25], v[24:25], v[28:29]
  s_waitcnt lgkmcnt(0)
  v_mul_f32 v24, s60, v24
  v_fma_f32 v26, v25, s60, v44
  v_pk_add_f32 v[16:17], v[16:17], v[18:19]
  v_fma_f32 v26, -v24, v24, v26
  v_add_f32 v16, v16, v17
  v_max_f32 v26, v44, v26
  v_rsq_f32 v26, v26
  v_fma_f32 v17, -v24, v60, v16
  v_fma_f32 v16, v17, v26, v61
  v_fma_f32 v20, v17, v26, v61
  s_nop 1
  v_mov_b32_dpp v20, v16 row_ror:8 row_mask:0xf bank_mask:0xc
  v_mul_f32 v18, v20, v20
  v_fma_f32 v19, v18, s61, v45
  v_mul_f32 v19, v19, v20
  v_exp_f32 v19, v19
  v_mul_f32_dpp v17, v16, v16 row_ror:8 row_mask:0xf bank_mask:0xf
  v_add_f32 v19, 1.0, v19
  v_rcp_f32 v19, v19
  s_nop 0
  v_mul_f32 v16, v17, v19
  s_nop 1
  v_mov_b32_dpp v17, v16 quad_perm:[1,1,3,3] row_mask:0xf bank_mask:0xf
  v_cvt_pk_bf16_f32 v17, v16, v17
  s_nop 1
  v_mov_b32_dpp v40, v17 quad_perm:[0,0,0,0] row_mask:0xf bank_mask:0x3
  v_mov_b32_dpp v41, v17 quad_perm:[2,2,2,2] row_mask:0xf bank_mask:0x3
  v_mov_b32_dpp v42, v17 quad_perm:[0,0,0,0] row_mask:0xf bank_mask:0xc
  v_mov_b32_dpp v43, v17 quad_perm:[2,2,2,2] row_mask:0xf bank_mask:0xc
  s_nop 1
  v_mfma_f32_16x16x32_bf16 v[24:27], v[40:43], v[112:115], 0
  v_mfma_f32_16x16x32_bf16 v[28:31], v[40:43], v[116:119], 0
  v_mfma_f32_16x16x32_bf16 v[32:35], v[40:43], v[120:123], 0
  v_mfma_f32_16x16x32_bf16 v[36:39], v[40:43], v[124:127], 0
  s_lshl_b32 s64, s4, 7
  s_lshl_b32 s65, s91, 2
  s_add_u32 s64, s64, s65
  s_add_u32 s64, s64, 63488
  s_cmp_lg_u32 s6, 0
  s_nop 0
  v_cvt_pk_bf16_f32 v64, v24, v28
  s_nop 0
  v_cvt_pk_bf16_f32 v65, v32, v36
  buffer_store_dwordx4 v[64:67], v63, s[8:11], s63 offen sc1
  s_nop 0
  s_cbranch_scc1 L_norn2
  s_mov_b64 exec, 1
  buffer_store_dword v66, v2, s[8:11], s64 offen
  s_mov_b64 exec, -1
L_norn2:
  s_branch L_done
L_NB:
  v_mul_u32_u24 v12, 1056, v6
  v_lshl_add_u32 v12, v7, 4, v12
  s_mul_i32 s65, s6, 33792
  s_add_u32 s65, s65, 26368
  v_add_u32 v9, s65, v12
  v_mul_u32_u24 v12, 1056, v6
  v_lshl_add_u32 v12, v7, 4, v12
  s_lshl_b32 s64, s6, 2
  v_add_u32 v59, s64, v14
  s_lshl_b32 s64, s6, 10
  v_add_u32 v60, s64, v8
  s_mov_b32 s60, 1040356334
  s_lshr_b32 s64, s6, 1
  s_lshl_b32 s66, s64, 2
  v_mov_b32 v36, s66
  s_mul_i32 s64, s64, 9472
  s_add_u32 s64, s64, 60160
  s_and_b32 s65, s6, 1
  s_lshl_b32 s65, s65, 3
  v_lshrrev_b32 v16, 3, v1
  v_add_u32 v16, s65, v16
  v_and_b32 v17, 7, v1
  v_mul_u32_u24 v32, 592, v16
  v_lshl_add_u32 v32, v17, 4, v32
  v_add_u32 v32, s64, v32
  v_mul_u32_u24 v34, 147456, v16
  v_lshl_add_u32 v34, v17, 4, v34
  v_mul_u32_u24 v35, 147456, v16
  v_lshl_add_u32 v35, v17, 3, v35
  v_lshlrev_b32 v33, 4, v16
  v_mul_u32_u24 v46, 17, v1
  v_sub_u32 v46, s47, v46
  v_and_b32 v46, 127, v46
  v_lshlrev_b32 v46, 7, v46
  v_lshl_add_u32 v46, v1, 2, v46
  s_mov_b32 s48, s38
  s_mov_b32 s49, s39
  s_mov_b32 s50, 3145728
  s_mov_b32 s51, 0x00020000
  s_and_b32 s64, s91, 7
  s_lshr_b32 s65, s91, 3
  s_lshl_b32 s66, s65, 2
  s_add_u32 s66, s66, s64
  v_lshrrev_b32 v250, 3, v1
  v_add_u32 v250, s66, v250
  v_and_b32 v250, 7, v250
  v_lshlrev_b32 v250, 6, v250
  v_and_b32 v251, 7, v1
  v_add_u32 v250, v251, v250
  s_and_b32 s67, s4, 1
  s_lshl_b32 s67, s67, 2
  s_add_u32 s67, s67, s6
  s_add_u32 s67, s67, s66
  s_and_b32 s67, s67, 7
  s_mul_i32 s67, s67, 49152
  s_lshl_b32 s64, s64, 2
  s_lshr_b32 s65, s4, 1
  s_add_u32 s64, s64, s65
  s_lshl_b32 s64, s64, 7
  s_add_u32 s67, s67, s64
  v_mul_u32_u24 v250, 6144, v250
  s_mov_b32 exec_hi, 0
  buffer_load_dword v251, v250, s[48:51], s67 offen offset:2048
  s_mov_b32 exec_hi, -1
L_wc_117:
  ds_read_b32 v4, v13 offset:26224
  s_waitcnt lgkmcnt(0)
  v_readfirstlane_b32 s68, v4
  s_cmp_ge_u32 s68, 1
  s_nop 2
  s_cbranch_scc1 L_wcd_118
  s_sleep 2
  s_sub_u32 s7, s7, 1
  s_cbranch_scc0 L_wc_117
  s_branch L_exit
L_wcd_118:
  s_waitcnt vmcnt(17)
  ds_read_b128 v[64:67], v9 offset:0
  ds_read_b128 v[68:71], v9 offset:64
  ds_read_b128 v[72:75], v9 offset:128
  ds_read_b128 v[76:79], v9 offset:192
  ds_read_b128 v[80:83], v9 offset:256
  ds_read_b128 v[84:87], v9 offset:320
  ds_read_b128 v[88:91], v9 offset:384
  ds_read_b128 v[92:95], v9 offset:448
  ds_read_b128 v[96:99], v9 offset:512
  ds_read_b128 v[100:103], v9 offset:576
  ds_read_b128 v[104:107], v9 offset:640
  ds_read_b128 v[108:111], v9 offset:704
  ds_read_b128 v[112:115], v9 offset:768
  ds_read_b128 v[116:119], v9 offset:832
  ds_read_b128 v[120:123], v9 offset:896
  ds_read_b128 v[124:127], v9 offset:960
  ds_add_u32 v15, v3 offset:26312
  s_waitcnt vmcnt(1)
  ds_add_u32 v15, v3 offset:26124
  ds_read_b128 v[128:131], v9 offset:16896
  ds_read_b128 v[132:135], v9 offset:16960
  ds_read_b128 v[136:139], v9 offset:17024
  ds_read_b128 v[140:143], v9 offset:17088
  ds_read_b128 v[144:147], v9 offset:17152
  ds_read_b128 v[148:151], v9 offset:17216
  ds_read_b128 v[152:155], v9 offset:17280
  ds_read_b128 v[156:159], v9 offset:17344
  ds_read_b128 v[160:163], v9 offset:17408
  ds_read_b128 v[164:167], v9 offset:17472
  ds_read_b128 v[168:171], v9 offset:17536
  ds_read_b128 v[172:175], v9 offset:17600
  ds_read_b128 v[176:179], v9 offset:17664
  ds_read_b128 v[180:183], v9 offset:17728
  ds_read_b128 v[184:187], v9 offset:17792
  ds_read_b128 v[188:191], v9 offset:17856
  ds_add_u32 v15, v3 offset:26128
  s_lshr_b32 s64, s47, 6
  s_lshl_b32 s64, s64, 1
  s_lshr_b32 s65, s6, 1
  s_add_u32 s64, s64, s65
  s_mul_i32 s64, s64, 36864
  s_add_u32 s64, s64, 2097152
  s_and_b32 s65, s47, 63
  s_lshl_b32 s66, s65, 9
  s_add_u32 s70, s64, s66
  s_add_u32 s71, s70, 2359296
  s_lshl_b32 s66, s65, 6
  s_add_u32 s72, s64, s66
  s_add_u32 s72, s72, 32768
  s_add_u32 s73, s72, 2359296
L_wc_119:
  ds_read_b32 v4, v2 offset:26132
  s_waitcnt lgkmcnt(0)
  v_readfirstlane_b32 s68, v4
  s_cmp_ge_u32 s68, 1
  s_nop 2
  s_cbranch_scc1 L_wcd_120
  s_sleep 1
  s_sub_u32 s7, s7, 1
  s_cbranch_scc0 L_wc_119
  s_branch L_exit
L_wcd_120:
  s_waitcnt vmcnt(0)
  s_setprio 2
  v_mov_b32 v40, 0x3f803f80
  v_mov_b32 v41, v40
  v_mov_b32 v42, v40
  v_mov_b32 v43, v40
  s_nop 1
L_wc_121:
  ds_read_b32 v4, v2 offset:26132
  ds_read_b32 v47, v2 offset:26304
  s_waitcnt lgkmcnt(0)
  v_readfirstlane_b32 s68, v4
  s_cmp_ge_u32 s68, 4
  s_nop 2
  s_cbranch_scc1 L_wcd_122
  s_sub_u32 s7, s7, 1
  s_cbranch_scc0 L_wc_121
  s_branch L_exit
L_wcd_122:
  ds_read_b128 v[192:195], v12 offset:0
  ds_read_b128 v[196:199], v12 offset:64
  ds_read_b128 v[200:203], v12 offset:128
  ds_read_b128 v[204:207], v12 offset:192
  ds_read_b128 v[208:211], v12 offset:256
  ds_read_b128 v[212:215], v12 offset:320
  v_readfirstlane_b32 s88, v47
  s_not_b32 s89, s88
  s_waitcnt lgkmcnt(5)
  v_mfma_f32_16x16x32_bf16 v[16:19], v[64:67], v[192:195], 0
  ds_read_b128 v[216:219], v12 offset:384
  v_mfma_f32_16x16x32_bf16 v[20:23], v[128:131], v[192:195], 0
  ds_read_b128 v[220:223], v12 offset:448
  s_waitcnt lgkmcnt(6)
  v_mfma_f32_16x16x32_bf16 v[16:19], v[68:71], v[196:199], v[16:19]
  ds_read_b128 v[224:227], v12 offset:512
  v_mfma_f32_16x16x32_bf16 v[20:23], v[132:135], v[196:199], v[20:23]
  ds_read_b128 v[228:231], v12 offset:576
  s_waitcnt lgkmcnt(7)
  v_mfma_f32_16x16x32_bf16 v[16:19], v[72:75], v[200:203], v[16:19]
  ds_read_b128 v[232:235], v12 offset:640
  v_mfma_f32_16x16x32_bf16 v[20:23], v[136:139], v[200:203], v[20:23]
  ds_read_b128 v[236:239], v12 offset:704
  s_waitcnt lgkmcnt(8)
  v_mfma_f32_16x16x32_bf16 v[16:19], v[76:79], v[204:207], v[16:19]
  ds_read_b128 v[240:243], v12 offset:768
  v_mfma_f32_16x16x32_bf16 v[20:23], v[140:143], v[204:207], v[20:23]
  ds_read_b128 v[244:247], v12 offset:832
  s_waitcnt lgkmcnt(9)
  v_mfma_f32_16x16x32_bf16 v[16:19], v[80:83], v[208:211], v[16:19]
  ds_read_b128 v[248:251], v12 offset:896
  v_mfma_f32_16x16x32_bf16 v[20:23], v[144:147], v[208:211], v[20:23]
  ds_read_b128 v[252:255], v12 offset:960
  s_waitcnt lgkmcnt(10)
  v_mfma_f32_16x16x32_bf16 v[16:19], v[84:87], v[212:215], v[16:19]
  v_mfma_f32_16x16x32_bf16 v[20:23], v[148:151], v[212:215], v[20:23]
  s_waitcnt lgkmcnt(8)
  v_mfma_f32_16x16x32_bf16 v[16:19], v[88:91], v[216:219], v[16:19]
  v_mfma_f32_16x16x32_bf16 v[20:23], v[152:155], v[216:219], v[20:23]
  v_mfma_f32_16x16x32_bf16 v[16:19], v[92:95], v[220:223], v[16:19]
  ds_read_b32 v4, v2 offset:26220
  v_mfma_f32_16x16x32_bf16 v[20:23], v[156:159], v[220:223], v[20:23]
  s_waitcnt lgkmcnt(7)
  v_mfma_f32_16x16x32_bf16 v[16:19], v[96:99], v[224:227], v[16:19]
  v_mfma_f32_16x16x32_bf16 v[20:23], v[160:163], v[224:227], v[20:23]
  v_mfma_f32_16x16x32_bf16 v[16:19], v[100:103], v[228:231], v[16:19]
  v_mfma_f32_16x16x32_bf16 v[20:23], v[164:167], v[228:231], v[20:23]
  s_waitcnt lgkmcnt(0)
  v_readfirstlane_b32 s68, v4
  v_mfma_f32_16x16x32_bf16 v[16:19], v[104:107], v[232:235], v[16:19]
  s_cmp_ge_u32 s68, 4
  s_cbranch_scc1 L_qbk_124
L_qsl_123:
  ds_read_b32 v4, v2 offset:26220
  s_waitcnt lgkmcnt(0)
  v_readfirstlane_b32 s68, v4
  s_cmp_ge_u32 s68, 4
  s_nop 2
  s_cbranch_scc1 L_qbk_124
  s_sub_u32 s7, s7, 1
  s_cbranch_scc0 L_qsl_123
  s_branch L_exit
L_qbk_124:
  v_mfma_f32_16x16x32_bf16 v[20:23], v[168:171], v[232:235], v[20:23]
  ds_read_b128 v[192:195], v12 offset:26368
  v_mfma_f32_16x16x32_bf16 v[16:19], v[108:111], v[236:239], v[16:19]
  ds_read_b128 v[196:199], v12 offset:26432
  v_mfma_f32_16x16x32_bf16 v[20:23], v[172:175], v[236:239], v[20:23]
  ds_read_b128 v[200:203], v12 offset:26496
  v_mfma_f32_16x16x32_bf16 v[16:19], v[112:115], v[240:243], v[16:19]
  ds_read_b128 v[204:207], v12 offset:26560
  v_mfma_f32_16x16x32_bf16 v[20:23], v[176:179], v[240:243], v[20:23]
  ds_read_b128 v[208:211], v12 offset:26624
  v_mfma_f32_16x16x32_bf16 v[16:19], v[116:119], v[244:247], v[16:19]
  ds_read_b128 v[212:215], v12 offset:26688
  v_mfma_f32_16x16x32_bf16 v[20:23], v[180:183], v[244:247], v[20:23]
  ds_read_b128 v[216:219], v12 offset:26752
  v_mfma_f32_16x16x32_bf16 v[16:19], v[120:123], v[248:251], v[16:19]
  ds_read_b128 v[220:223], v12 offset:26816
  v_mfma_f32_16x16x32_bf16 v[20:23], v[184:187], v[248:251], v[20:23]
  ds_read_b128 v[224:227], v12 offset:26880
  v_mfma_f32_16x16x32_bf16 v[16:19], v[124:127], v[252:255], v[16:19]
  ds_read_b128 v[228:231], v12 offset:26944
  v_mfma_f32_16x16x32_bf16 v[20:23], v[188:191], v[252:255], v[20:23]
  ds_read_b128 v[232:235], v12 offset:27008
  s_waitcnt lgkmcnt(8)
  v_mfma_f32_16x16x32_bf16 v[24:27], v[64:67], v[192:195], 0
  ds_read_b128 v[236:239], v12 offset:27072
  v_mfma_f32_16x16x32_bf16 v[28:31], v[128:131], v[192:195], 0
  ds_read_b128 v[240:243], v12 offset:27136
  v_mfma_f32_16x16x32_bf16 v[24:27], v[68:71], v[196:199], v[24:27]
  ds_read_b128 v[244:247], v12 offset:27200
  v_max3_f32 v56, v16, v17, v18
  v_mfma_f32_16x16x32_bf16 v[28:31], v[132:135], v[196:199], v[28:31]
  ds_read_b128 v[248:251], v12 offset:27264
  v_max3_f32 v57, v19, v20, v21
  v_mfma_f32_16x16x32_bf16 v[24:27], v[72:75], v[200:203], v[24:27]
  ds_read_b128 v[252:255], v12 offset:27328
  v_max3_f32 v57, v57, v22, v23
  v_mfma_f32_16x16x32_bf16 v[28:31], v[136:139], v[200:203], v[28:31]
  s_waitcnt lgkmcnt(10)
  v_max_f32 v61, v56, v57
  v_max_f32 v62, v56, v57
  v_mfma_f32_16x16x32_bf16 v[24:27], v[76:79], v[204:207], v[24:27]
  s_nop 0
  v_permlane16_swap_b32 v61, v62
  v_mfma_f32_16x16x32_bf16 v[28:31], v[140:143], v[204:207], v[28:31]
  v_max_f32 v56, v61, v62
  v_max_f32 v57, v61, v62
  v_mfma_f32_16x16x32_bf16 v[24:27], v[80:83], v[208:211], v[24:27]
  s_nop 0
  v_permlane32_swap_b32 v56, v57
  v_mfma_f32_16x16x32_bf16 v[28:31], v[144:147], v[208:211], v[28:31]
  s_waitcnt lgkmcnt(0)
  v_max_f32 v56, v56, v57
  v_mul_f32 v56, s60, v56
  v_mfma_f32_16x16x32_bf16 v[24:27], v[84:87], v[212:215], v[24:27]
  v_ceil_f32 v56, v56
  v_fma_f32 v16, v16, s60, -v56
  v_mfma_f32_16x16x32_bf16 v[28:31], v[148:151], v[212:215], v[28:31]
  ds_write_b32 v59, v56 offset:25088
  v_fma_f32 v17, v17, s60, -v56
  v_mfma_f32_16x16x32_bf16 v[24:27], v[88:91], v[216:219], v[24:27]
  ds_add_u32 v15, v3 offset:26136
  v_fma_f32 v18, v18, s60, -v56
  v_mfma_f32_16x16x32_bf16 v[28:31], v[152:155], v[216:219], v[28:31]
  v_fma_f32 v19, v19, s60, -v56
  v_fma_f32 v20, v20, s60, -v56
  v_mfma_f32_16x16x32_bf16 v[24:27], v[92:95], v[220:223], v[24:27]
  v_fma_f32 v21, v21, s60, -v56
  v_fma_f32 v22, v22, s60, -v56
  v_mfma_f32_16x16x32_bf16 v[28:31], v[156:159], v[220:223], v[28:31]
  v_fma_f32 v23, v23, s60, -v56
  v_mfma_f32_16x16x32_bf16 v[24:27], v[96:99], v[224:227], v[24:27]
  v_exp_f32 v16, v16
  v_mfma_f32_16x16x32_bf16 v[28:31], v[160:163], v[224:227], v[28:31]
  v_exp_f32 v17, v17
  v_mfma_f32_16x16x32_bf16 v[24:27], v[100:103], v[228:231], v[24:27]
  v_exp_f32 v18, v18
  v_mfma_f32_16x16x32_bf16 v[28:31], v[164:167], v[228:231], v[28:31]
  v_exp_f32 v19, v19
  v_mfma_f32_16x16x32_bf16 v[24:27], v[104:107], v[232:235], v[24:27]
  v_exp_f32 v20, v20
  v_mfma_f32_16x16x32_bf16 v[28:31], v[168:171], v[232:235], v[28:31]
  v_exp_f32 v21, v21
  v_mfma_f32_16x16x32_bf16 v[24:27], v[108:111], v[236:239], v[24:27]
  v_exp_f32 v22, v22
  v_mfma_f32_16x16x32_bf16 v[28:31], v[172:175], v[236:239], v[28:31]
  v_exp_f32 v23, v23
  v_mfma_f32_16x16x32_bf16 v[24:27], v[112:115], v[240:243], v[24:27]
  v_cvt_pk_bf16_f32 v52, v16, v17
  v_cvt_pk_bf16_f32 v53, v18, v19
  v_mfma_f32_16x16x32_bf16 v[28:31], v[176:179], v[240:243], v[28:31]
  v_cvt_pk_bf16_f32 v54, v20, v21
  v_cvt_pk_bf16_f32 v55, v22, v23
  v_mfma_f32_16x16x32_bf16 v[24:27], v[116:119], v[244:247], v[24:27]
  ds_write_b128 v60, v[52:55] offset:16896
  v_mfma_f32_16x16x32_bf16 v[28:31], v[180:183], v[244:247], v[28:31]
  ds_add_u32 v15, v3 offset:26144
  v_mfma_f32_16x16x32_bf16 v[16:19], v[40:43], v[52:55], 0
  v_mfma_f32_16x16x32_bf16 v[24:27], v[120:123], v[248:251], v[24:27]
  v_mfma_f32_16x16x32_bf16 v[28:31], v[184:187], v[248:251], v[28:31]
  v_mfma_f32_16x16x32_bf16 v[24:27], v[124:127], v[252:255], v[24:27]
  v_mfma_f32_16x16x32_bf16 v[28:31], v[188:191], v[252:255], v[28:31]
  s_nop 7
L_qkj:
  ds_write_b32 v59, v16 offset:25600
  v_max3_f32 v56, v24, v25, v26
  v_max3_f32 v57, v27, v28, v29
  v_max3_f32 v57, v57, v30, v31
  v_max_f32 v61, v56, v57
  v_max_f32 v62, v56, v57
  s_nop 1
  v_permlane16_swap_b32 v61, v62
  v_max_f32 v56, v61, v62
  v_max_f32 v57, v61, v62
  s_nop 1
  v_permlane32_swap_b32 v56, v57
  v_max_f32 v56, v56, v57
  v_mul_f32 v56, s60, v56
  v_ceil_f32 v56, v56
  ds_write_b32 v59, v56 offset:25344
  ds_add_u32 v15, v3 offset:26140
  ds_add_u32 v15, v3 offset:26188
  v_fma_f32 v24, v24, s60, -v56
  v_fma_f32 v25, v25, s60, -v56
  v_fma_f32 v26, v26, s60, -v56
  v_fma_f32 v27, v27, s60, -v56
  v_fma_f32 v28, v28, s60, -v56
  v_fma_f32 v29, v29, s60, -v56
  v_fma_f32 v30, v30, s60, -v56
  v_fma_f32 v31, v31, s60, -v56
  v_exp_f32 v24, v24
  v_exp_f32 v25, v25
  v_exp_f32 v26, v26
  v_exp_f32 v27, v27
  v_exp_f32 v28, v28
  v_exp_f32 v29, v29
  v_exp_f32 v30, v30
  v_exp_f32 v31, v31
  v_cvt_pk_bf16_f32 v52, v24, v25
  v_cvt_pk_bf16_f32 v53, v26, v27
  v_cvt_pk_bf16_f32 v54, v28, v29
  v_cvt_pk_bf16_f32 v55, v30, v31
  ds_write_b128 v60, v[52:55] offset:20992
  ds_add_u32 v15, v3 offset:26148
  v_mfma_f32_16x16x32_bf16 v[24:27], v[40:43], v[52:55], 0
  ds_read_b32 v4, v36 offset:26320
  ds_read_b128 v[64:67], v32
  ds_read_b128 v[68:71], v32 offset:256
  s_nop 4
  ds_write_b32 v59, v24 offset:25856
  ds_add_u32 v15, v3 offset:26192
  s_setprio 0
  s_mov_b32 s74, 0xaaaaaaaa
  s_mov_b32 s75, 0xaaaaaaaa
  s_mov_b32 s80, 0xcccccccc
  s_mov_b32 s81, 0xcccccccc
  s_lshl_b32 s61, s4, 8
  s_lshl_b32 s65, s91, 4
  s_add_u32 s61, s61, s65
  s_lshl_b32 s65, s6, 2
  s_add_u32 s61, s61, s65
  s_add_u32 s61, s61, 55296
  v_mov_b32 v45, s88
  v_and_b32 v26, 4, v1
  v_lshl_add_u32 v33, v26, 6, v33
  s_nop 1
L_wc_125:
  ds_read_b32 v4, v2 offset:26192
  ds_read_b128 v[16:19], v33 offset:25088
  ds_read_b128 v[20:23], v33 offset:25600
  s_waitcnt lgkmcnt(0)
  v_readfirstlane_b32 s68, v4
  s_cmp_ge_u32 s68, 4
  s_nop 2
  s_cbranch_scc1 L_wcd_126
  s_sub_u32 s7, s7, 1
  s_cbranch_scc0 L_wc_125
  s_branch L_exit
L_wcd_126:
  v_max3_f32 v24, v16, v17, v18
  v_max_f32 v24, v24, v19
  v_sub_f32 v16, v16, v24
  v_sub_f32 v17, v17, v24
  v_sub_f32 v18, v18, v24
  v_sub_f32 v19, v19, v24
  v_cvt_i32_f32 v16, v16
  v_cvt_i32_f32 v17, v17
  v_cvt_i32_f32 v18, v18
  v_cvt_i32_f32 v19, v19
  ds_read_b32 v4, v36 offset:26320
  ds_read_b128 v[64:67], v32 offset:0
  ds_read_b128 v[68:71], v32 offset:256
  v_ldexp_f32 v20, v20, v16
  v_ldexp_f32 v21, v21, v17
  v_ldexp_f32 v22, v22, v18
  v_ldexp_f32 v23, v23, v19
  v_add_f32 v20, v20, v21
  v_add_f32 v22, v22, v23
  v_add_f32 v20, v20, v22
  v_cvt_i32_f32 v24, v24
  v_xor_b32 v24, 0x80000000, v24
  v_cndmask_b32 v38, v24, v20, s[80:81]
  s_nop 1
  v_mov_b32_dpp v39, v38 row_shl:4 row_mask:0xf bank_mask:0xf bound_ctrl:0
  s_waitcnt lgkmcnt(0)
  v_readfirstlane_b32 s68, v4
  s_cmp_ge_u32 s68, 2
  s_nop 2
  s_cbranch_scc1 L_b2_127
L_wc_128:
  ds_read_b32 v4, v36 offset:26320
  ds_read_b128 v[64:67], v32 offset:0
  ds_read_b128 v[68:71], v32 offset:256
  s_waitcnt lgkmcnt(0)
  v_readfirstlane_b32 s68, v4
  s_cmp_ge_u32 s68, 2
  s_nop 2
  s_cbranch_scc1 L_wcd_129
  s_sub_u32 s7, s7, 1
  s_cbranch_scc0 L_wc_128
  s_branch L_exit
L_wcd_129:
L_b2_127:
  buffer_store_dwordx4 v[64:67], v34, s[8:11], s70 offen offset:0 sc1
  buffer_store_dwordx4 v[68:71], v34, s[8:11], s70 offen offset:256 sc1
  ds_read_b32 v4, v36 offset:26328
  ds_read_b128 v[72:75], v32 offset:128
  ds_read_b128 v[76:79], v32 offset:384
  v_bitop3_b32 v40, s88, v64, v66 bitop3:0x96
  v_bitop3_b32 v41, v65, v67, v69 bitop3:0x96
  v_bitop3_b32 v40, v40, v68, v70 bitop3:0x96
  v_xor_b32 v41, v41, v71
  v_xor_b32 v37, s89, v38
  s_waitcnt lgkmcnt(0)
  v_readfirstlane_b32 s68, v4
  s_cmp_ge_u32 s68, 2
  s_nop 2
  s_cbranch_scc1 L_b2_130
L_wc_131:
  ds_read_b32 v4, v36 offset:26328
  ds_read_b128 v[72:75], v32 offset:128
  ds_read_b128 v[76:79], v32 offset:384
  s_waitcnt lgkmcnt(0)
  v_readfirstlane_b32 s68, v4
  s_cmp_ge_u32 s68, 2
  s_nop 2
  s_cbranch_scc1 L_wcd_132
  s_sub_u32 s7, s7, 1
  s_cbranch_scc0 L_wc_131
  s_branch L_exit
L_wcd_132:
L_b2_130:
  buffer_store_dwordx4 v[72:75], v34, s[8:11], s70 offen offset:128 sc1
  buffer_store_dwordx4 v[76:79], v34, s[8:11], s70 offen offset:384 sc1
  ds_read_b32 v4, v36 offset:26336
  ds_read_b128 v[80:83], v32 offset:18944
  ds_read_b128 v[84:87], v32 offset:19200
  v_bitop3_b32 v41, v41, v73, v75 bitop3:0x96
  v_bitop3_b32 v40, v40, v72, v74 bitop3:0x96
  v_bitop3_b32 v41, v41, v77, v79 bitop3:0x96
  v_bitop3_b32 v40, v40, v76, v78 bitop3:0x96
  v_xor_b32 v37, v37, v41
  s_nop 1
  v_xor_b32_dpp v41, v41, v37 quad_perm:[1,0,3,2] row_mask:0xf bank_mask:0xf
  v_cndmask_b32 v41, v38, v41, s[74:75]
  buffer_store_dwordx2 v[40:41], v35, s[8:11], s72 offen sc1
  s_waitcnt lgkmcnt(0)
  v_readfirstlane_b32 s68, v4
  s_cmp_ge_u32 s68, 2
  s_nop 2
  s_cbranch_scc1 L_b2_133
L_wc_134:
  ds_read_b32 v4, v36 offset:26336
  ds_read_b128 v[80:83], v32 offset:18944
  ds_read_b128 v[84:87], v32 offset:19200
  s_waitcnt lgkmcnt(0)
  v_readfirstlane_b32 s68, v4
  s_cmp_ge_u32 s68, 2
  s_nop 2
  s_cbranch_scc1 L_wcd_135
  s_sub_u32 s7, s7, 1
  s_cbranch_scc0 L_wc_134
  s_branch L_exit
L_wcd_135:
L_b2_133:
  buffer_store_dwordx4 v[80:83], v34, s[8:11], s71 offen offset:0 sc1
  buffer_store_dwordx4 v[84:87], v34, s[8:11], s71 offen offset:256 sc1
  ds_read_b32 v4, v36 offset:26344
  ds_read_b128 v[88:91], v32 offset:19072
  ds_read_b128 v[92:95], v32 offset:19328
  v_bitop3_b32 v42, s88, v80, v82 bitop3:0x96
  v_bitop3_b32 v43, v81, v83, v85 bitop3:0x96
  v_bitop3_b32 v42, v42, v84, v86 bitop3:0x96
  v_xor_b32 v43, v43, v87
  v_xor_b32 v37, s89, v39
  s_mov_b64 exec, 1
  buffer_store_dword v45, v2, s[8:11], s61 offen
  s_mov_b64 exec, -1
  s_waitcnt lgkmcnt(0)
  v_readfirstlane_b32 s68, v4
  s_cmp_ge_u32 s68, 2
  s_nop 2
  s_cbranch_scc1 L_b2_136
L_wc_137:
  ds_read_b32 v4, v36 offset:26344
  ds_read_b128 v[88:91], v32 offset:19072
  ds_read_b128 v[92:95], v32 offset:19328
  s_waitcnt lgkmcnt(0)
  v_readfirstlane_b32 s68, v4
  s_cmp_ge_u32 s68, 2
  s_nop 2
  s_cbranch_scc1 L_wcd_138
  s_sub_u32 s7, s7, 1
  s_cbranch_scc0 L_wc_137
  s_branch L_exit
L_wcd_138:
L_b2_136:
  buffer_store_dwordx4 v[88:91], v34, s[8:11], s71 offen offset:128 sc1
  buffer_store_dwordx4 v[92:95], v34, s[8:11], s71 offen offset:384 sc1
  v_bitop3_b32 v43, v43, v89, v91 bitop3:0x96
  v_bitop3_b32 v42, v42, v88, v90 bitop3:0x96
  v_bitop3_b32 v43, v43, v93, v95 bitop3:0x96
  v_bitop3_b32 v42, v42, v92, v94 bitop3:0x96
  v_xor_b32 v37, v37, v43
  s_nop 1
  v_xor_b32_dpp v43, v43, v37 quad_perm:[1,0,3,2] row_mask:0xf bank_mask:0xf
  v_cndmask_b32 v43, v39, v43, s[74:75]
  buffer_store_dwordx2 v[42:43], v35, s[8:11], s73 offen sc1
  s_setprio 0
  ds_add_u32 v15, v3 offset:26196
  s_lshl_b32 s64, s4, 8
  s_lshl_b32 s65, s91, 4
  s_add_u32 s64, s64, s65
  s_lshl_b32 s65, s6, 2
  s_add_u32 s64, s64, s65
  s_add_u32 s64, s64, 53248
  v_mov_b32 v47, s88
  s_waitcnt vmcnt(3)
  s_mov_b64 exec, 1
  buffer_store_dword v47, v2, s[8:11], s64 offen
  s_mov_b64 exec, -1
  s_cmp_lg_u32 s6, 3
  s_cbranch_scc1 L_nohint
  v_mov_b32 v47, s88
  s_mov_b64 exec, 0xff
  buffer_store_dword v47, v46, s[8:11], 0 offen sc1
  s_mov_b64 exec, -1
L_nohint:
  s_cmp_ge_u32 s91, 14
  s_cbranch_scc1 L_done
  v_lshlrev_b32 v13, 4, v10
  s_mov_b32 s48, s16
  s_mov_b32 s49, s17
  s_mov_b32 s50, 2048
  s_mov_b32 s51, 0x00020000
  v_lshrrev_b32 v16, 3, v6
  v_and_b32 v17, 7, v1
  v_lshl_add_u32 v17, v7, 3, v17
  s_lshl_b32 s64, s6, 5
  v_add_u32 v17, s64, v17
  v_lshlrev_b32 v18, 4, v17
  v_lshl_add_u32 v13, v16, 11, v18
  v_lshl_add_u32 v18, v16, 13, v18
  v_lshlrev_b32 v17, 3, v17
  v_lshl_add_u32 v19, v16, 10, v17
  v_mul_u32_u24 v248, 1040, v16
  v_add_u32 v248, v248, v17
  s_lshl_b32 s64, s6, 3
  v_lshl_add_u32 v14, v16, 5, s64
  s_lshl_b32 s64, s6, 2
  v_mov_b32 v12, 0x7ff00000
  v_writelane_b32 v12, s64, 0
  s_movk_i32 s54, 0x3f80
  s_mov_b32 s55, 0x3f800000
  buffer_load_dwordx2 v[20:21], v19, s[48:51], 0 offen
  s_mov_b32 s66, 1183744
  buffer_load_dwordx4 v[64:67], v18, s[8:11], s66 offen sc1
  s_mov_b32 s66, 1200128
  buffer_load_dwordx4 v[68:71], v18, s[8:11], s66 offen sc1
  s_mov_b32 s66, 1216512
  buffer_load_dwordx4 v[72:75], v18, s[8:11], s66 offen sc1
  s_mov_b32 s66, 1232896
  buffer_load_dwordx4 v[76:79], v18, s[8:11], s66 offen sc1
  s_mov_b32 s66, 1181696
  buffer_load_dwordx4 v[80:83], v18, s[8:11], s66 offen sc1
  s_mov_b32 s66, 1198080
  buffer_load_dwordx4 v[84:87], v18, s[8:11], s66 offen sc1
  s_mov_b32 s66, 1214464
  buffer_load_dwordx4 v[88:91], v18, s[8:11], s66 offen sc1
  s_mov_b32 s66, 1230848
  buffer_load_dwordx4 v[92:95], v18, s[8:11], s66 offen sc1
  s_mov_b32 s66, 1179648
  buffer_load_dwordx4 v[96:99], v18, s[8:11], s66 offen sc1
  s_mov_b32 s66, 1196032
  buffer_load_dwordx4 v[100:103], v18, s[8:11], s66 offen sc1
  s_mov_b32 s66, 1212416
  buffer_load_dwordx4 v[104:107], v18, s[8:11], s66 offen sc1
  s_mov_b32 s66, 1228800
  buffer_load_dwordx4 v[108:111], v18, s[8:11], s66 offen sc1
  s_waitcnt vmcnt(4)
  ds_add_u32 v15, v3 offset:26156
  s_mov_b64 s[70:71], -1
  s_mov_b64 s[72:73], -1
  s_mov_b64 s[74:75], -1
  s_mov_b64 s[76:77], -1
  s_mov_b64 s[78:79], -1
  s_mov_b64 s[80:81], -1
  s_mov_b64 s[82:83], -1
  s_mov_b64 s[84:85], -1
  s_branch L_gw_141
L_gpo_143:
L_gp_139:
  s_mov_b64 exec, s[70:71]
  s_cbranch_execz L_gs_144
  s_mov_b32 s66, 1183744
  buffer_load_dwordx4 v[64:67], v18, s[8:11], s66 offen sc1
L_gs_144:
  s_mov_b64 exec, s[72:73]
  s_cbranch_execz L_gs_145
  s_mov_b32 s66, 1200128
  buffer_load_dwordx4 v[68:71], v18, s[8:11], s66 offen sc1
L_gs_145:
  s_mov_b64 exec, s[74:75]
  s_cbranch_execz L_gs_146
  s_mov_b32 s66, 1216512
  buffer_load_dwordx4 v[72:75], v18, s[8:11], s66 offen sc1
L_gs_146:
  s_mov_b64 exec, s[76:77]
  s_cbranch_execz L_gs_147
  s_mov_b32 s66, 1232896
  buffer_load_dwordx4 v[76:79], v18, s[8:11], s66 offen sc1
L_gs_147:
  s_mov_b64 exec, s[78:79]
  s_cbranch_execz L_gs_148
  s_mov_b32 s66, 1181696
  buffer_load_dwordx4 v[80:83], v18, s[8:11], s66 offen sc1
L_gs_148:
  s_mov_b64 exec, s[80:81]
  s_cbranch_execz L_gs_149
  s_mov_b32 s66, 1198080
  buffer_load_dwordx4 v[84:87], v18, s[8:11], s66 offen sc1
L_gs_149:
  s_mov_b64 exec, s[82:83]
  s_cbranch_execz L_gs_150
  s_mov_b32 s66, 1214464
  buffer_load_dwordx4 v[88:91], v18, s[8:11], s66 offen sc1
L_gs_150:
  s_mov_b64 exec, s[84:85]
  s_cbranch_execz L_gs_151
  s_mov_b32 s66, 1230848
  buffer_load_dwordx4 v[92:95], v18, s[8:11], s66 offen sc1
L_gs_151:
L_gw_141:
  s_waitcnt vmcnt(0)
  s_mov_b64 exec, s[70:71]
  v_cmp_ne_u64_e64 s[70:71], s[88:89], v[66:67]
  s_mov_b64 exec, s[72:73]
  v_cmp_ne_u64_e64 s[72:73], s[88:89], v[70:71]
  s_mov_b64 exec, s[74:75]
  v_cmp_ne_u64_e64 s[74:75], s[88:89], v[74:75]
  s_mov_b64 exec, s[76:77]
  v_cmp_ne_u64_e64 s[76:77], s[88:89], v[78:79]
  s_mov_b64 exec, s[78:79]
  v_cmp_ne_u64_e64 s[78:79], s[88:89], v[82:83]
  s_mov_b64 exec, s[80:81]
  v_cmp_ne_u64_e64 s[80:81], s[88:89], v[86:87]
  s_mov_b64 exec, s[82:83]
  v_cmp_ne_u64_e64 s[82:83], s[88:89], v[90:91]
  s_mov_b64 exec, s[84:85]
  v_cmp_ne_u64_e64 s[84:85], s[88:89], v[94:95]
  s_mov_b64 exec, -1
  s_mov_b64 s[68:69], s[70:71]
  s_or_b64 s[68:69], s[68:69], s[72:73]
  s_or_b64 s[68:69], s[68:69], s[74:75]
  s_or_b64 s[68:69], s[68:69], s[76:77]
  s_or_b64 s[68:69], s[68:69], s[78:79]
  s_or_b64 s[68:69], s[68:69], s[80:81]
  s_or_b64 s[68:69], s[68:69], s[82:83]
  s_or_b64 s[68:69], s[68:69], s[84:85]
  s_cmp_eq_u64 s[68:69], 0
  s_cbranch_scc1 L_gpd_140
  s_sub_u32 s7, s7, 1
  s_cbranch_scc1 L_exit
  s_bcnt1_i32_b64 s67, s[68:69]
  s_cmp_le_u32 s67, 16
  s_cbranch_scc1 L_gp_139
L_gse_142:
  s_cmp_eq_u64 s[70:71], 0
  s_cbranch_scc1 L_gn_152
  s_and_b64 s[68:69], s[70:71], s[96:97]
  s_cselect_b64 s[68:69], s[68:69], s[70:71]
  s_ff1_i32_b64 s68, s[68:69]
  s_lshl_b64 exec, 1, s68
L_gsp_153:
  s_mov_b32 s66, 1183744
  buffer_load_dwordx4 v[64:67], v18, s[8:11], s66 offen sc1
  s_waitcnt vmcnt(0)
  v_cmp_eq_u64 vcc, s[88:89], v[66:67]
  s_nop 0
  s_cbranch_vccnz L_gpo_143
  s_sleep 1
  s_sub_u32 s7, s7, 1
  s_cbranch_scc0 L_gsp_153
  s_branch L_exit
L_gn_152:
  s_cmp_eq_u64 s[72:73], 0
  s_cbranch_scc1 L_gn_154
  s_and_b64 s[68:69], s[72:73], s[96:97]
  s_cselect_b64 s[68:69], s[68:69], s[72:73]
  s_ff1_i32_b64 s68, s[68:69]
  s_lshl_b64 exec, 1, s68
L_gsp_155:
  s_mov_b32 s66, 1200128
  buffer_load_dwordx4 v[68:71], v18, s[8:11], s66 offen sc1
  s_waitcnt vmcnt(0)
  v_cmp_eq_u64 vcc, s[88:89], v[70:71]
  s_nop 0
  s_cbranch_vccnz L_gpo_143
  s_sleep 1
  s_sub_u32 s7, s7, 1
  s_cbranch_scc0 L_gsp_155
  s_branch L_exit
L_gn_154:
  s_cmp_eq_u64 s[74:75], 0
  s_cbranch_scc1 L_gn_156
  s_and_b64 s[68:69], s[74:75], s[96:97]
  s_cselect_b64 s[68:69], s[68:69], s[74:75]
  s_ff1_i32_b64 s68, s[68:69]
  s_lshl_b64 exec, 1, s68
L_gsp_157:
  s_mov_b32 s66, 1216512
  buffer_load_dwordx4 v[72:75], v18, s[8:11], s66 offen sc1
  s_waitcnt vmcnt(0)
  v_cmp_eq_u64 vcc, s[88:89], v[74:75]
  s_nop 0
  s_cbranch_vccnz L_gpo_143
  s_sleep 1
  s_sub_u32 s7, s7, 1
  s_cbranch_scc0 L_gsp_157
  s_branch L_exit
L_gn_156:
  s_cmp_eq_u64 s[76:77], 0
  s_cbranch_scc1 L_gn_158
  s_and_b64 s[68:69], s[76:77], s[96:97]
  s_cselect_b64 s[68:69], s[68:69], s[76:77]
  s_ff1_i32_b64 s68, s[68:69]
  s_lshl_b64 exec, 1, s68
L_gsp_159:
  s_mov_b32 s66, 1232896
  buffer_load_dwordx4 v[76:79], v18, s[8:11], s66 offen sc1
  s_waitcnt vmcnt(0)
  v_cmp_eq_u64 vcc, s[88:89], v[78:79]
  s_nop 0
  s_cbranch_vccnz L_gpo_143
  s_sleep 1
  s_sub_u32 s7, s7, 1
  s_cbranch_scc0 L_gsp_159
  s_branch L_exit
L_gn_158:
  s_cmp_eq_u64 s[78:79], 0
  s_cbranch_scc1 L_gn_160
  s_and_b64 s[68:69], s[78:79], s[96:97]
  s_cselect_b64 s[68:69], s[68:69], s[78:79]
  s_ff1_i32_b64 s68, s[68:69]
  s_lshl_b64 exec, 1, s68
L_gsp_161:
  s_mov_b32 s66, 1181696
  buffer_load_dwordx4 v[80:83], v18, s[8:11], s66 offen sc1
  s_waitcnt vmcnt(0)
  v_cmp_eq_u64 vcc, s[88:89], v[82:83]
  s_nop 0
  s_cbranch_vccnz L_gpo_143
  s_sleep 1
  s_sub_u32 s7, s7, 1
  s_cbranch_scc0 L_gsp_161
  s_branch L_exit
L_gn_160:
  s_cmp_eq_u64 s[80:81], 0
  s_cbranch_scc1 L_gn_162
  s_and_b64 s[68:69], s[80:81], s[96:97]
  s_cselect_b64 s[68:69], s[68:69], s[80:81]
  s_ff1_i32_b64 s68, s[68:69]
  s_lshl_b64 exec, 1, s68
L_gsp_163:
  s_mov_b32 s66, 1198080
  buffer_load_dwordx4 v[84:87], v18, s[8:11], s66 offen sc1
  s_waitcnt vmcnt(0)
  v_cmp_eq_u64 vcc, s[88:89], v[86:87]
  s_nop 0
  s_cbranch_vccnz L_gpo_143
  s_sleep 1
  s_sub_u32 s7, s7, 1
  s_cbranch_scc0 L_gsp_163
  s_branch L_exit
L_gn_162:
  s_cmp_eq_u64 s[82:83], 0
  s_cbranch_scc1 L_gn_164
  s_and_b64 s[68:69], s[82:83], s[96:97]
  s_cselect_b64 s[68:69], s[68:69], s[82:83]
  s_ff1_i32_b64 s68, s[68:69]
  s_lshl_b64 exec, 1, s68
L_gsp_165:
  s_mov_b32 s66, 1214464
  buffer_load_dwordx4 v[88:91], v18, s[8:11], s66 offen sc1
  s_waitcnt vmcnt(0)
  v_cmp_eq_u64 vcc, s[88:89], v[90:91]
  s_nop 0
  s_cbranch_vccnz L_gpo_143
  s_sleep 1
  s_sub_u32 s7, s7, 1
  s_cbranch_scc0 L_gsp_165
  s_branch L_exit
L_gn_164:
  s_cmp_eq_u64 s[84:85], 0
  s_cbranch_scc1 L_gn_166
  s_and_b64 s[68:69], s[84:85], s[96:97]
  s_cselect_b64 s[68:69], s[68:69], s[84:85]
  s_ff1_i32_b64 s68, s[68:69]
  s_lshl_b64 exec, 1, s68
L_gsp_167:
  s_mov_b32 s66, 1230848
  buffer_load_dwordx4 v[92:95], v18, s[8:11], s66 offen sc1
  s_waitcnt vmcnt(0)
  v_cmp_eq_u64 vcc, s[88:89], v[94:95]
  s_nop 0
  s_cbranch_vccnz L_gpo_143
  s_sleep 1
  s_sub_u32 s7, s7, 1
  s_cbranch_scc0 L_gsp_167
  s_branch L_exit
L_gn_166:
L_gpd_140:
  s_mov_b64 s[70:71], -1
  s_mov_b64 s[72:73], -1
  s_mov_b64 s[74:75], -1
  s_mov_b64 s[76:77], -1
  s_branch L_gw_170
L_gpo_172:
L_gp_168:
  s_mov_b64 exec, s[70:71]
  s_cbranch_execz L_gs_173
  s_mov_b32 s66, 1179648
  buffer_load_dwordx4 v[96:99], v18, s[8:11], s66 offen sc1
L_gs_173:
  s_mov_b64 exec, s[72:73]
  s_cbranch_execz L_gs_174
  s_mov_b32 s66, 1196032
  buffer_load_dwordx4 v[100:103], v18, s[8:11], s66 offen sc1
L_gs_174:
  s_mov_b64 exec, s[74:75]
  s_cbranch_execz L_gs_175
  s_mov_b32 s66, 1212416
  buffer_load_dwordx4 v[104:107], v18, s[8:11], s66 offen sc1
L_gs_175:
  s_mov_b64 exec, s[76:77]
  s_cbranch_execz L_gs_176
  s_mov_b32 s66, 1228800
  buffer_load_dwordx4 v[108:111], v18, s[8:11], s66 offen sc1
L_gs_176:
L_gw_170:
  s_waitcnt vmcnt(0)
  s_mov_b64 exec, s[70:71]
  v_cmp_ne_u64_e64 s[70:71], s[88:89], v[98:99]
  s_mov_b64 exec, s[72:73]
  v_cmp_ne_u64_e64 s[72:73], s[88:89], v[102:103]
  s_mov_b64 exec, s[74:75]
  v_cmp_ne_u64_e64 s[74:75], s[88:89], v[106:107]
  s_mov_b64 exec, s[76:77]
  v_cmp_ne_u64_e64 s[76:77], s[88:89], v[110:111]
  s_mov_b64 exec, -1
  s_mov_b64 s[68:69], s[70:71]
  s_or_b64 s[68:69], s[68:69], s[72:73]
  s_or_b64 s[68:69], s[68:69], s[74:75]
  s_or_b64 s[68:69], s[68:69], s[76:77]
  s_cmp_eq_u64 s[68:69], 0
  s_cbranch_scc1 L_gpd_169
  s_sub_u32 s7, s7, 1
  s_cbranch_scc1 L_exit
  s_bcnt1_i32_b64 s67, s[68:69]
  s_cmp_le_u32 s67, 16
  s_cbranch_scc1 L_gp_168
L_gse_171:
  s_cmp_eq_u64 s[70:71], 0
  s_cbranch_scc1 L_gn_177
  s_and_b64 s[68:69], s[70:71], s[96:97]
  s_cselect_b64 s[68:69], s[68:69], s[70:71]
  s_ff1_i32_b64 s68, s[68:69]
  s_lshl_b64 exec, 1, s68
L_gsp_178:
  s_mov_b32 s66, 1179648
  buffer_load_dwordx4 v[96:99], v18, s[8:11], s66 offen sc1
  s_waitcnt vmcnt(0)
  v_cmp_eq_u64 vcc, s[88:89], v[98:99]
  s_nop 0
  s_cbranch_vccnz L_gpo_172
  s_sleep 1
  s_sub_u32 s7, s7, 1
  s_cbranch_scc0 L_gsp_178
  s_branch L_exit
L_gn_177:
  s_cmp_eq_u64 s[72:73], 0
  s_cbranch_scc1 L_gn_179
  s_and_b64 s[68:69], s[72:73], s[96:97]
  s_cselect_b64 s[68:69], s[68:69], s[72:73]
  s_ff1_i32_b64 s68, s[68:69]
  s_lshl_b64 exec, 1, s68
L_gsp_180:
  s_mov_b32 s66, 1196032
  buffer_load_dwordx4 v[100:103], v18, s[8:11], s66 offen sc1
  s_waitcnt vmcnt(0)
  v_cmp_eq_u64 vcc, s[88:89], v[102:103]
  s_nop 0
  s_cbranch_vccnz L_gpo_172
  s_sleep 1
  s_sub_u32 s7, s7, 1
  s_cbranch_scc0 L_gsp_180
  s_branch L_exit
L_gn_179:
  s_cmp_eq_u64 s[74:75], 0
  s_cbranch_scc1 L_gn_181
  s_and_b64 s[68:69], s[74:75], s[96:97]
  s_cselect_b64 s[68:69], s[68:69], s[74:75]
  s_ff1_i32_b64 s68, s[68:69]
  s_lshl_b64 exec, 1, s68
L_gsp_182:
  s_mov_b32 s66, 1212416
  buffer_load_dwordx4 v[104:107], v18, s[8:11], s66 offen sc1
  s_waitcnt vmcnt(0)
  v_cmp_eq_u64 vcc, s[88:89], v[106:107]
  s_nop 0
  s_cbranch_vccnz L_gpo_172
  s_sleep 1
  s_sub_u32 s7, s7, 1
  s_cbranch_scc0 L_gsp_182
  s_branch L_exit
L_gn_181:
  s_cmp_eq_u64 s[76:77], 0
  s_cbranch_scc1 L_gn_183
  s_and_b64 s[68:69], s[76:77], s[96:97]
  s_cselect_b64 s[68:69], s[68:69], s[76:77]
  s_ff1_i32_b64 s68, s[68:69]
  s_lshl_b64 exec, 1, s68
L_gsp_184:
  s_mov_b32 s66, 1228800
  buffer_load_dwordx4 v[108:111], v18, s[8:11], s66 offen sc1
  s_waitcnt vmcnt(0)
  v_cmp_eq_u64 vcc, s[88:89], v[110:111]
  s_nop 0
  s_cbranch_vccnz L_gpo_172
  s_sleep 1
  s_sub_u32 s7, s7, 1
  s_cbranch_scc0 L_gsp_184
  s_branch L_exit
L_gn_183:
L_gpd_169:
  v_mov_b32 v24, 1.0
  v_mov_b32 v25, 1.0
  v_mov_b32 v26, 1.0
  v_mov_b32 v27, 1.0
  v_dot2c_f32_bf16 v24, s54, v64
  v_dot2c_f32_bf16 v25, s55, v64
  v_dot2c_f32_bf16 v26, s54, v65
  v_dot2c_f32_bf16 v27, s55, v65
  v_dot2c_f32_bf16 v24, s54, v68
  v_dot2c_f32_bf16 v25, s55, v68
  v_dot2c_f32_bf16 v26, s54, v69
  v_dot2c_f32_bf16 v27, s55, v69
  v_dot2c_f32_bf16 v24, s54, v72
  v_dot2c_f32_bf16 v25, s55, v72
  v_dot2c_f32_bf16 v26, s54, v73
  v_dot2c_f32_bf16 v27, s55, v73
  v_dot2c_f32_bf16 v24, s54, v76
  v_dot2c_f32_bf16 v25, s55, v76
  v_dot2c_f32_bf16 v26, s54, v77
  v_dot2c_f32_bf16 v27, s55, v77
  v_mov_b32 v28, 0
  v_mov_b32 v29, 0
  v_mov_b32 v30, 0
  v_mov_b32 v31, 0
  v_dot2c_f32_bf16 v28, s54, v80
  v_dot2c_f32_bf16 v29, s55, v80
  v_dot2c_f32_bf16 v30, s54, v81
  v_dot2c_f32_bf16 v31, s55, v81
  v_dot2c_f32_bf16 v28, s54, v84
  v_dot2c_f32_bf16 v29, s55, v84
  v_dot2c_f32_bf16 v30, s54, v85
  v_dot2c_f32_bf16 v31, s55, v85
  v_dot2c_f32_bf16 v28, s54, v88
  v_dot2c_f32_bf16 v29, s55, v88
  v_dot2c_f32_bf16 v30, s54, v89
  v_dot2c_f32_bf16 v31, s55, v89
  v_dot2c_f32_bf16 v28, s54, v92
  v_dot2c_f32_bf16 v29, s55, v92
  v_dot2c_f32_bf16 v30, s54, v93
  v_dot2c_f32_bf16 v31, s55, v93
  v_mov_b32 v32, 0
  v_mov_b32 v33, 0
  v_mov_b32 v34, 0
  v_mov_b32 v35, 0
  v_dot2c_f32_bf16 v32, s54, v96
  v_dot2c_f32_bf16 v33, s55, v96
  v_dot2c_f32_bf16 v34, s54, v97
  v_dot2c_f32_bf16 v35, s55, v97
  v_dot2c_f32_bf16 v32, s54, v100
  v_dot2c_f32_bf16 v33, s55, v100
  v_dot2c_f32_bf16 v34, s54, v101
  v_dot2c_f32_bf16 v35, s55, v101
  v_dot2c_f32_bf16 v32, s54, v104
  v_dot2c_f32_bf16 v33, s55, v104
  v_dot2c_f32_bf16 v34, s54, v105
  v_dot2c_f32_bf16 v35, s55, v105
  v_dot2c_f32_bf16 v32, s54, v108
  v_dot2c_f32_bf16 v33, s55, v108
  v_dot2c_f32_bf16 v34, s54, v109
  v_dot2c_f32_bf16 v35, s55, v109
  v_cvt_pk_bf16_f32 v36, v24, v25
  v_cvt_pk_bf16_f32 v37, v26, v27
  v_cvt_pk_bf16_f32 v38, v28, v29
  v_cvt_pk_bf16_f32 v39, v30, v31
  ds_write_b64 v248, v[36:37] offset:0
  ds_write_b64 v248, v[38:39] offset:2080
  v_lshlrev_b32 v24, 16, v36
  v_and_b32 v25, 0xffff0000, v36
  v_lshlrev_b32 v26, 16, v37
  v_and_b32 v27, 0xffff0000, v37
  v_lshlrev_b32 v28, 16, v20
  v_and_b32 v29, 0xffff0000, v20
  v_lshlrev_b32 v30, 16, v21
  v_and_b32 v31, 0xffff0000, v21
  v_mov_b32 v36, 0
  v_mov_b32 v37, 0
  v_mov_b32 v38, 0
  v_mov_b32 v39, 0
  ds_add_u32 v15, v3 offset:26152
  s_lshl_b32 s64, s6, 2
  v_mov_b32 v59, s64
  s_lshl_b32 s64, s6, 13
  s_add_u32 s64, s64, 121088
  v_lshrrev_b32 v44, 2, v6
  v_lshl_add_u32 v44, v7, 3, v44
  v_lshlrev_b32 v44, 5, v44
  v_and_b32 v11, 3, v6
  v_lshl_add_u32 v44, v11, 3, v44
  v_add_u32 v44, s64, v44
  v_mul_u32_u24 v11, 1040, v11
  v_lshl_add_u32 v11, v7, 4, v11
  s_lshl_b32 s64, s6, 8
  v_add_u32 v11, s64, v11
  s_lshl_b32 s64, s6, 2
  s_add_u32 s64, s64, 10496
  v_lshl_add_u32 v62, v6, 4, s64
  v_mul_u32_u24 v11, 1792, v7
  v_add_u32 v44, v44, v11
  v_lshrrev_b32 v11, 5, v1
  v_lshl_add_u32 v14, v11, 2, v14
  v_mul_u32_u24 v11, 320, v11
  v_add_u32 v62, v62, v11
  v_mov_b32 v11, 0x7ff00000
  v_and_b32 v45, 0x17, v1
  v_cmp_eq_u32 vcc, 0, v45
  s_nop 1
  v_cndmask_b32 v14, v11, v14, vcc
  v_and_b32 v45, 16, v1
  v_cmp_eq_u32 vcc, 0, v45
  s_nop 1
  v_cndmask_b32 v62, v11, v62, vcc
  v_mul_f32 v40, v24, v28
  v_mul_f32 v41, v25, v29
  v_mul_f32 v42, v26, v30
  v_mul_f32 v43, v27, v31
  v_mul_f32 v24, v24, v32
  v_mul_f32 v25, v25, v33
  v_mul_f32 v26, v26, v34
  v_mul_f32 v27, v27, v35
  s_nop 1
L_wc_185:
  ds_read_b32 v4, v59 offset:26272
  s_waitcnt lgkmcnt(0)
  v_readfirstlane_b32 s68, v4
  s_cmp_ge_u32 s68, 1
  s_nop 2
  s_cbranch_scc1 L_wcd_186
  s_sleep 2
  s_sub_u32 s7, s7, 1
  s_cbranch_scc0 L_wc_185
  s_branch L_exit
L_wcd_186:
  ds_read_b64_tr_b16 v[128:129], v44 offset:0
  ds_read_b64_tr_b16 v[130:131], v44 offset:128
  ds_read_b64_tr_b16 v[132:133], v44 offset:1024
  ds_read_b64_tr_b16 v[134:135], v44 offset:1152
  ds_read_b64_tr_b16 v[136:137], v44 offset:256
  ds_read_b64_tr_b16 v[138:139], v44 offset:384
  ds_read_b64_tr_b16 v[140:141], v44 offset:1280
  ds_read_b64_tr_b16 v[142:143], v44 offset:1408
  ds_read_b64_tr_b16 v[144:145], v44 offset:512
  ds_read_b64_tr_b16 v[146:147], v44 offset:640
  ds_read_b64_tr_b16 v[148:149], v44 offset:1536
  ds_read_b64_tr_b16 v[150:151], v44 offset:1664
  ds_read_b64_tr_b16 v[152:153], v44 offset:768
  ds_read_b64_tr_b16 v[154:155], v44 offset:896
  ds_read_b64_tr_b16 v[156:157], v44 offset:1792
  ds_read_b64_tr_b16 v[158:159], v44 offset:1920
  s_waitcnt lgkmcnt(0)
  s_mov_b64 s[70:71], -1
  s_mov_b64 s[72:73], -1
  s_mov_b64 s[74:75], -1
  s_mov_b64 s[76:77], -1
  s_mov_b64 s[78:79], -1
  s_mov_b64 s[80:81], -1
  s_mov_b64 s[82:83], -1
  s_mov_b64 s[84:85], -1
  s_bfe_u32 s66, s95, 0x20002
  s_cmp_lg_u32 s66, 3
  s_cbranch_scc1 L_gse_190
L_gpo_191:
  s_mov_b64 exec, s[70:71]
  s_mov_b32 s66, 262144
  buffer_load_dwordx4 v[64:67], v13, s[8:11], s66 offen sc1
  s_mov_b64 exec, s[72:73]
  s_mov_b32 s66, 266240
  buffer_load_dwordx4 v[68:71], v13, s[8:11], s66 offen sc1
  s_mov_b64 exec, s[74:75]
  s_mov_b32 s66, 270336
  buffer_load_dwordx4 v[72:75], v13, s[8:11], s66 offen sc1
  s_mov_b64 exec, s[76:77]
  s_mov_b32 s66, 274432
  buffer_load_dwordx4 v[76:79], v13, s[8:11], s66 offen sc1
  s_mov_b64 exec, s[78:79]
  s_mov_b32 s66, 278528
  buffer_load_dwordx4 v[80:83], v13, s[8:11], s66 offen sc1
  s_mov_b64 exec, s[80:81]
  s_mov_b32 s66, 282624
  buffer_load_dwordx4 v[84:87], v13, s[8:11], s66 offen sc1
  s_mov_b64 exec, s[82:83]
  s_mov_b32 s66, 286720
  buffer_load_dwordx4 v[88:91], v13, s[8:11], s66 offen sc1
  s_mov_b64 exec, s[84:85]
  s_mov_b32 s66, 290816
  buffer_load_dwordx4 v[92:95], v13, s[8:11], s66 offen sc1
  s_mov_b64 exec, -1
  s_nop 1
  v_mov_b32 v36, 0
  v_mov_b32 v37, 0
  v_mov_b32 v38, 0
  v_mov_b32 v39, 0
  s_waitcnt vmcnt(7)
  v_cmp_ne_u64_e64 s[70:71], s[88:89], v[66:67]
  v_dot2c_f32_bf16 v36, s54, v64
  v_dot2c_f32_bf16 v37, s55, v64
  v_dot2c_f32_bf16 v38, s54, v65
  v_dot2c_f32_bf16 v39, s55, v65
  s_waitcnt vmcnt(6)
  v_cmp_ne_u64_e64 s[72:73], s[88:89], v[70:71]
  v_dot2c_f32_bf16 v36, s54, v68
  v_dot2c_f32_bf16 v37, s55, v68
  v_dot2c_f32_bf16 v38, s54, v69
  v_dot2c_f32_bf16 v39, s55, v69
  s_or_b64 s[68:69], s[70:71], s[72:73]
  s_waitcnt vmcnt(5)
  v_cmp_ne_u64_e64 s[74:75], s[88:89], v[74:75]
  v_dot2c_f32_bf16 v36, s54, v72
  v_dot2c_f32_bf16 v37, s55, v72
  v_dot2c_f32_bf16 v38, s54, v73
  v_dot2c_f32_bf16 v39, s55, v73
  s_or_b64 s[68:69], s[68:69], s[74:75]
  s_waitcnt vmcnt(4)
  v_cmp_ne_u64_e64 s[76:77], s[88:89], v[78:79]
  v_dot2c_f32_bf16 v36, s54, v76
  v_dot2c_f32_bf16 v37, s55, v76
  v_dot2c_f32_bf16 v38, s54, v77
  v_dot2c_f32_bf16 v39, s55, v77
  s_or_b64 s[68:69], s[68:69], s[76:77]
  s_waitcnt vmcnt(3)
  v_cmp_ne_u64_e64 s[78:79], s[88:89], v[82:83]
  v_dot2c_f32_bf16 v36, s54, v80
  v_dot2c_f32_bf16 v37, s55, v80
  v_dot2c_f32_bf16 v38, s54, v81
  v_dot2c_f32_bf16 v39, s55, v81
  s_or_b64 s[68:69], s[68:69], s[78:79]
  s_waitcnt vmcnt(2)
  v_cmp_ne_u64_e64 s[80:81], s[88:89], v[86:87]
  v_dot2c_f32_bf16 v36, s54, v84
  v_dot2c_f32_bf16 v37, s55, v84
  v_dot2c_f32_bf16 v38, s54, v85
  v_dot2c_f32_bf16 v39, s55, v85
  s_or_b64 s[68:69], s[68:69], s[80:81]
  s_waitcnt vmcnt(1)
  v_cmp_ne_u64_e64 s[82:83], s[88:89], v[90:91]
  v_dot2c_f32_bf16 v36, s54, v88
  v_dot2c_f32_bf16 v37, s55, v88
  v_dot2c_f32_bf16 v38, s54, v89
  v_dot2c_f32_bf16 v39, s55, v89
  s_or_b64 s[68:69], s[68:69], s[82:83]
  s_waitcnt vmcnt(0)
  v_cmp_ne_u64_e64 s[84:85], s[88:89], v[94:95]
  v_dot2c_f32_bf16 v36, s54, v92
  v_dot2c_f32_bf16 v37, s55, v92
  v_dot2c_f32_bf16 v38, s54, v93
  v_dot2c_f32_bf16 v39, s55, v93
  s_or_b64 s[68:69], s[68:69], s[84:85]
  s_cbranch_scc0 L_xpf
  s_sub_u32 s7, s7, 1
  s_cbranch_scc0 L_gpo_191
  s_branch L_exit
L_gpo_192:
L_gp_187:
  s_mov_b64 exec, s[70:71]
  s_cbranch_execz L_gs_193
  s_mov_b32 s66, 262144
  buffer_load_dwordx4 v[64:67], v13, s[8:11], s66 offen sc1
L_gs_193:
  s_mov_b64 exec, s[72:73]
  s_cbranch_execz L_gs_194
  s_mov_b32 s66, 266240
  buffer_load_dwordx4 v[68:71], v13, s[8:11], s66 offen sc1
L_gs_194:
  s_mov_b64 exec, s[74:75]
  s_cbranch_execz L_gs_195
  s_mov_b32 s66, 270336
  buffer_load_dwordx4 v[72:75], v13, s[8:11], s66 offen sc1
L_gs_195:
  s_mov_b64 exec, s[76:77]
  s_cbranch_execz L_gs_196
  s_mov_b32 s66, 274432
  buffer_load_dwordx4 v[76:79], v13, s[8:11], s66 offen sc1
L_gs_196:
  s_mov_b64 exec, s[78:79]
  s_cbranch_execz L_gs_197
  s_mov_b32 s66, 278528
  buffer_load_dwordx4 v[80:83], v13, s[8:11], s66 offen sc1
L_gs_197:
  s_mov_b64 exec, s[80:81]
  s_cbranch_execz L_gs_198
  s_mov_b32 s66, 282624
  buffer_load_dwordx4 v[84:87], v13, s[8:11], s66 offen sc1
L_gs_198:
  s_mov_b64 exec, s[82:83]
  s_cbranch_execz L_gs_199
  s_mov_b32 s66, 286720
  buffer_load_dwordx4 v[88:91], v13, s[8:11], s66 offen sc1
L_gs_199:
  s_mov_b64 exec, s[84:85]
  s_cbranch_execz L_gs_200
  s_mov_b32 s66, 290816
  buffer_load_dwordx4 v[92:95], v13, s[8:11], s66 offen sc1
L_gs_200:
L_gw_189:
  s_waitcnt vmcnt(0)
  s_mov_b64 exec, s[70:71]
  v_cmp_ne_u64_e64 s[70:71], s[88:89], v[66:67]
  s_mov_b64 exec, s[72:73]
  v_cmp_ne_u64_e64 s[72:73], s[88:89], v[70:71]
  s_mov_b64 exec, s[74:75]
  v_cmp_ne_u64_e64 s[74:75], s[88:89], v[74:75]
  s_mov_b64 exec, s[76:77]
  v_cmp_ne_u64_e64 s[76:77], s[88:89], v[78:79]
  s_mov_b64 exec, s[78:79]
  v_cmp_ne_u64_e64 s[78:79], s[88:89], v[82:83]
  s_mov_b64 exec, s[80:81]
  v_cmp_ne_u64_e64 s[80:81], s[88:89], v[86:87]
  s_mov_b64 exec, s[82:83]
  v_cmp_ne_u64_e64 s[82:83], s[88:89], v[90:91]
  s_mov_b64 exec, s[84:85]
  v_cmp_ne_u64_e64 s[84:85], s[88:89], v[94:95]
  s_mov_b64 exec, -1
  s_mov_b64 s[68:69], s[70:71]
  s_or_b64 s[68:69], s[68:69], s[72:73]
  s_or_b64 s[68:69], s[68:69], s[74:75]
  s_or_b64 s[68:69], s[68:69], s[76:77]
  s_or_b64 s[68:69], s[68:69], s[78:79]
  s_or_b64 s[68:69], s[68:69], s[80:81]
  s_or_b64 s[68:69], s[68:69], s[82:83]
  s_or_b64 s[68:69], s[68:69], s[84:85]
  s_cmp_eq_u64 s[68:69], 0
  s_cbranch_scc1 L_gpd_188
  s_sub_u32 s7, s7, 1
  s_cbranch_scc1 L_exit
  s_bcnt1_i32_b64 s67, s[68:69]
  s_cmp_le_u32 s67, 64
  s_cbranch_scc1 L_gp_187
L_gse_190:
  s_cmp_eq_u64 s[70:71], 0
  s_cbranch_scc1 L_gn_201
  s_and_b64 s[68:69], s[70:71], s[96:97]
  s_cselect_b64 s[68:69], s[68:69], s[70:71]
  s_ff1_i32_b64 s68, s[68:69]
  s_lshl_b64 exec, 1, s68
L_gsp_202:
  s_mov_b32 s66, 262144
  buffer_load_dwordx4 v[64:67], v13, s[8:11], s66 offen sc1
  s_waitcnt vmcnt(0)
  v_cmp_eq_u64 vcc, s[88:89], v[66:67]
  s_nop 0
  s_cbranch_vccnz L_gpo_191
  s_sleep 1
  s_sub_u32 s7, s7, 1
  s_cbranch_scc0 L_gsp_202
  s_branch L_exit
L_gn_201:
  s_cmp_eq_u64 s[72:73], 0
  s_cbranch_scc1 L_gn_203
  s_and_b64 s[68:69], s[72:73], s[96:97]
  s_cselect_b64 s[68:69], s[68:69], s[72:73]
  s_ff1_i32_b64 s68, s[68:69]
  s_lshl_b64 exec, 1, s68
L_gsp_204:
  s_mov_b32 s66, 266240
  buffer_load_dwordx4 v[68:71], v13, s[8:11], s66 offen sc1
  s_waitcnt vmcnt(0)
  v_cmp_eq_u64 vcc, s[88:89], v[70:71]
  s_nop 0
  s_cbranch_vccnz L_gpo_191
  s_sleep 1
  s_sub_u32 s7, s7, 1
  s_cbranch_scc0 L_gsp_204
  s_branch L_exit
L_gn_203:
  s_cmp_eq_u64 s[74:75], 0
  s_cbranch_scc1 L_gn_205
  s_and_b64 s[68:69], s[74:75], s[96:97]
  s_cselect_b64 s[68:69], s[68:69], s[74:75]
  s_ff1_i32_b64 s68, s[68:69]
  s_lshl_b64 exec, 1, s68
L_gsp_206:
  s_mov_b32 s66, 270336
  buffer_load_dwordx4 v[72:75], v13, s[8:11], s66 offen sc1
  s_waitcnt vmcnt(0)
  v_cmp_eq_u64 vcc, s[88:89], v[74:75]
  s_nop 0
  s_cbranch_vccnz L_gpo_191
  s_sleep 1
  s_sub_u32 s7, s7, 1
  s_cbranch_scc0 L_gsp_206
  s_branch L_exit
L_gn_205:
  s_cmp_eq_u64 s[76:77], 0
  s_cbranch_scc1 L_gn_207
  s_and_b64 s[68:69], s[76:77], s[96:97]
  s_cselect_b64 s[68:69], s[68:69], s[76:77]
  s_ff1_i32_b64 s68, s[68:69]
  s_lshl_b64 exec, 1, s68
L_gsp_208:
  s_mov_b32 s66, 274432
  buffer_load_dwordx4 v[76:79], v13, s[8:11], s66 offen sc1
  s_waitcnt vmcnt(0)
  v_cmp_eq_u64 vcc, s[88:89], v[78:79]
  s_nop 0
  s_cbranch_vccnz L_gpo_191
  s_sleep 1
  s_sub_u32 s7, s7, 1
  s_cbranch_scc0 L_gsp_208
  s_branch L_exit
L_gn_207:
  s_cmp_eq_u64 s[78:79], 0
  s_cbranch_scc1 L_gn_209
  s_and_b64 s[68:69], s[78:79], s[96:97]
  s_cselect_b64 s[68:69], s[68:69], s[78:79]
  s_ff1_i32_b64 s68, s[68:69]
  s_lshl_b64 exec, 1, s68
L_gsp_210:
  s_mov_b32 s66, 278528
  buffer_load_dwordx4 v[80:83], v13, s[8:11], s66 offen sc1
  s_waitcnt vmcnt(0)
  v_cmp_eq_u64 vcc, s[88:89], v[82:83]
  s_nop 0
  s_cbranch_vccnz L_gpo_191
  s_sleep 1
  s_sub_u32 s7, s7, 1
  s_cbranch_scc0 L_gsp_210
  s_branch L_exit
L_gn_209:
  s_cmp_eq_u64 s[80:81], 0
  s_cbranch_scc1 L_gn_211
  s_and_b64 s[68:69], s[80:81], s[96:97]
  s_cselect_b64 s[68:69], s[68:69], s[80:81]
  s_ff1_i32_b64 s68, s[68:69]
  s_lshl_b64 exec, 1, s68
L_gsp_212:
  s_mov_b32 s66, 282624
  buffer_load_dwordx4 v[84:87], v13, s[8:11], s66 offen sc1
  s_waitcnt vmcnt(0)
  v_cmp_eq_u64 vcc, s[88:89], v[86:87]
  s_nop 0
  s_cbranch_vccnz L_gpo_191
  s_sleep 1
  s_sub_u32 s7, s7, 1
  s_cbranch_scc0 L_gsp_212
  s_branch L_exit
L_gn_211:
  s_cmp_eq_u64 s[82:83], 0
  s_cbranch_scc1 L_gn_213
  s_and_b64 s[68:69], s[82:83], s[96:97]
  s_cselect_b64 s[68:69], s[68:69], s[82:83]
  s_ff1_i32_b64 s68, s[68:69]
  s_lshl_b64 exec, 1, s68
L_gsp_214:
  s_mov_b32 s66, 286720
  buffer_load_dwordx4 v[88:91], v13, s[8:11], s66 offen sc1
  s_waitcnt vmcnt(0)
  v_cmp_eq_u64 vcc, s[88:89], v[90:91]
  s_nop 0
  s_cbranch_vccnz L_gpo_191
  s_sleep 1
  s_sub_u32 s7, s7, 1
  s_cbranch_scc0 L_gsp_214
  s_branch L_exit
L_gn_213:
  s_cmp_eq_u64 s[84:85], 0
  s_cbranch_scc1 L_gn_215
  s_and_b64 s[68:69], s[84:85], s[96:97]
  s_cselect_b64 s[68:69], s[68:69], s[84:85]
  s_ff1_i32_b64 s68, s[68:69]
  s_lshl_b64 exec, 1, s68
L_gsp_216:
  s_mov_b32 s66, 290816
  buffer_load_dwordx4 v[92:95], v13, s[8:11], s66 offen sc1
  s_waitcnt vmcnt(0)
  v_cmp_eq_u64 vcc, s[88:89], v[94:95]
  s_nop 0
  s_cbranch_vccnz L_gpo_191
  s_sleep 1
  s_sub_u32 s7, s7, 1
  s_cbranch_scc0 L_gsp_216
  s_branch L_exit
L_gn_215:
L_gpd_188:
  v_dot2c_f32_bf16 v36, s54, v64
  v_dot2c_f32_bf16 v37, s55, v64
  v_dot2c_f32_bf16 v38, s54, v65
  v_dot2c_f32_bf16 v39, s55, v65
  v_dot2c_f32_bf16 v36, s54, v68
  v_dot2c_f32_bf16 v37, s55, v68
  v_dot2c_f32_bf16 v38, s54, v69
  v_dot2c_f32_bf16 v39, s55, v69
  v_dot2c_f32_bf16 v36, s54, v72
  v_dot2c_f32_bf16 v37, s55, v72
  v_dot2c_f32_bf16 v38, s54, v73
  v_dot2c_f32_bf16 v39, s55, v73
  v_dot2c_f32_bf16 v36, s54, v76
  v_dot2c_f32_bf16 v37, s55, v76
  v_dot2c_f32_bf16 v38, s54, v77
  v_dot2c_f32_bf16 v39, s55, v77
  v_dot2c_f32_bf16 v36, s54, v80
  v_dot2c_f32_bf16 v37, s55, v80
  v_dot2c_f32_bf16 v38, s54, v81
  v_dot2c_f32_bf16 v39, s55, v81
  v_dot2c_f32_bf16 v36, s54, v84
  v_dot2c_f32_bf16 v37, s55, v84
  v_dot2c_f32_bf16 v38, s54, v85
  v_dot2c_f32_bf16 v39, s55, v85
  v_dot2c_f32_bf16 v36, s54, v88
  v_dot2c_f32_bf16 v37, s55, v88
  v_dot2c_f32_bf16 v38, s54, v89
  v_dot2c_f32_bf16 v39, s55, v89
  v_dot2c_f32_bf16 v36, s54, v92
  v_dot2c_f32_bf16 v37, s55, v92
  v_dot2c_f32_bf16 v38, s54, v93
  v_dot2c_f32_bf16 v39, s55, v93
  s_nop 1
L_xpf:
  s_nop 0
  s_waitcnt lgkmcnt(0)
  v_fmac_f32 v40, v24, v36
  v_fmac_f32 v41, v25, v37
  v_fmac_f32 v42, v26, v38
  v_fmac_f32 v43, v27, v39
  v_cvt_pk_bf16_f32 v96, v40, v41
  v_cvt_pk_bf16_f32 v97, v42, v43
  v_fmac_f32 v28, v32, v36
  v_fmac_f32 v29, v33, v37
  v_mov_b32_dpp v98, v96 row_shl:1 row_mask:0xf bank_mask:0xf bound_ctrl:0
  v_mov_b32_dpp v99, v97 row_shl:1 row_mask:0xf bank_mask:0xf bound_ctrl:0
  v_mov_b32_dpp v100, v96 row_shl:2 row_mask:0xf bank_mask:0xf bound_ctrl:0
  v_mov_b32_dpp v101, v97 row_shl:2 row_mask:0xf bank_mask:0xf bound_ctrl:0
  v_mfma_f32_16x16x32_bf16 v[48:51], v[96:99], v[128:131], 0
  v_mov_b32_dpp v102, v96 row_shl:3 row_mask:0xf bank_mask:0xf bound_ctrl:0
  v_mov_b32_dpp v103, v97 row_shl:3 row_mask:0xf bank_mask:0xf bound_ctrl:0
  v_mfma_f32_16x16x32_bf16 v[52:55], v[96:99], v[132:135], 0
  v_fmac_f32 v30, v34, v38
  v_fmac_f32 v31, v35, v39
  v_add_f32 v24, v28, v29
  v_mul_f32 v25, v28, v28
  v_mfma_f32_16x16x32_bf16 v[48:51], v[100:103], v[136:139], v[48:51]
  v_add_f32 v26, v30, v31
  v_fmac_f32 v25, v29, v29
  v_add_f32 v24, v24, v26
  v_fmac_f32 v25, v30, v30
  v_mfma_f32_16x16x32_bf16 v[52:55], v[100:103], v[140:143], v[52:55]
  v_fmac_f32 v25, v31, v31
  v_mov_b32_dpp v104, v96 row_shl:4 row_mask:0xf bank_mask:0xf bound_ctrl:0
  v_mov_b32_dpp v105, v97 row_shl:4 row_mask:0xf bank_mask:0xf bound_ctrl:0
  v_permlane32_swap_b32 v24, v25
  v_mov_b32_dpp v106, v96 row_shl:5 row_mask:0xf bank_mask:0xf bound_ctrl:0
  v_mov_b32_dpp v107, v97 row_shl:5 row_mask:0xf bank_mask:0xf bound_ctrl:0
  v_add_f32 v24, v24, v25
  v_mov_b32_dpp v108, v96 row_shl:6 row_mask:0xf bank_mask:0xf bound_ctrl:0
  v_mfma_f32_16x16x32_bf16 v[48:51], v[104:107], v[144:147], v[48:51]
  v_add_f32_dpp v24, v24, v24 quad_perm:[1,0,3,2] row_mask:0xf bank_mask:0xf
  v_mov_b32_dpp v109, v97 row_shl:6 row_mask:0xf bank_mask:0xf bound_ctrl:0
  v_mfma_f32_16x16x32_bf16 v[52:55], v[104:107], v[148:151], v[52:55]
  v_add_f32_dpp v24, v24, v24 quad_perm:[2,3,0,1] row_mask:0xf bank_mask:0xf
  v_mov_b32_dpp v110, v96 row_shl:7 row_mask:0xf bank_mask:0xf bound_ctrl:0
  v_mov_b32_dpp v111, v97 row_shl:7 row_mask:0xf bank_mask:0xf bound_ctrl:0
  v_add_f32_dpp v25, v24, v24 row_half_mirror row_mask:0xf bank_mask:0xf
  v_add_f32_dpp v24, v24, v24 row_half_mirror row_mask:0xf bank_mask:0xf
  v_mfma_f32_16x16x32_bf16 v[48:51], v[108:111], v[152:155], v[48:51]
  v_mfma_f32_16x16x32_bf16 v[52:55], v[108:111], v[156:159], v[52:55]
  v_permlane16_swap_b32 v24, v25
  v_add_f32 v24, v24, v25
  ds_write_b32 v14, v24 offset:8320
  s_nop 4
  ds_write2_b32 v62, v48, v52 offset0:0 offset1:160
  s_waitcnt lgkmcnt(0)
  s_barrier
  s_branch L_done
L_done:
  s_waitcnt lgkmcnt(0)
L_exit:
  s_endpgm
.section .rodata,"a"
.p2align 6
.amdhsa_kernel adaLN_cond__compressed_kv_cla__glu_gated_geglu__decode_kernel
  .amdhsa_next_free_vgpr 256
  .amdhsa_next_free_sgpr 102
  .amdhsa_accum_offset 256
  .amdhsa_group_segment_fixed_size 0
  .amdhsa_kernarg_size 120
  .amdhsa_user_sgpr_count 2
  .amdhsa_user_sgpr_kernarg_segment_ptr 1
  .amdhsa_system_sgpr_workgroup_id_x 1
.end_amdhsa_kernel
```
